```python
import torch

def _softmax(x, axis=-1):
    return torch.softmax(x, dim=axis)
def _gelu(x):
    return torch.nn.functional.gelu(x, approximate="tanh")
def _silu(x):
    return torch.nn.functional.silu(x)
def _sigmoid(x):
    return torch.sigmoid(x)
def _layernorm(x, axis=-1, eps=1e-5):
    m = x.mean(dim=axis, keepdim=True)
    v = x.var(dim=axis, keepdim=True, unbiased=False)
    return (x - m) / torch.sqrt(v + eps)
def _scatter_add(tgt, idx, src, axis=0):
    return tgt.clone().index_add_(axis, idx, src)
def _segment_sum(src, seg, n):
    out = torch.zeros((n,) + src.shape[1:], dtype=src.dtype)
    return out.index_add_(0, seg, src)
def _pad(x, pw):
    flat = tuple(v for pair in reversed(pw) for v in pair)
    return torch.nn.functional.pad(x, flat)

kernel_name = 'concat_heads__ssm_conv_h3__sliding_local_dilated__prompt'

def setup_inputs():

    _w = (lambda a: (lambda t: t.to(torch.bfloat16) if t.is_floating_point() else t)(torch.as_tensor(a)))
    def _A_setup():
        B, S, D = 1, 2048, 576
        ks = 4
        return {
            "q": _w((lambda *s: torch.randn(*s, dtype=torch.bfloat16) * 0.05)(B, S, D)),
            "k": _w((lambda *s: torch.randn(*s, dtype=torch.bfloat16) * 0.8)(B, S, D)),
            "v": _w((lambda *s: torch.randn(*s, dtype=torch.bfloat16) * 0.8)(B, S, D)),
            "shift_k": _w((lambda *s: torch.randn(*s, dtype=torch.bfloat16) * 0.8)(D, ks) * 0.5),
            "ssm_k": _w((lambda *s: torch.randn(*s, dtype=torch.bfloat16) * 1.6)(D, S) * (1.0 / S ** 0.5)),
            "ssm_D": _w((lambda *s: torch.randn(*s, dtype=torch.bfloat16) * 0.8)(D)),
        }
    _A_in = _A_setup()

    def _B_setup():
        B, S, D = 1, 2048, 576
        return {
            "x": _w((lambda *s: torch.randn(*s, dtype=torch.bfloat16) * 0.2)(B, S, D)),
            "wqkv": _w((lambda *s: torch.randn(*s, dtype=torch.bfloat16) * 0.2)(D, 3 * D)),
            "wo": _w((lambda *s: torch.randn(*s, dtype=torch.bfloat16) * 0.05)(D, D)),
        }
    _B_in = _B_setup()

    return {
        "A_q": _A_in["q"],
        "A_k": _A_in["k"],
        "A_v": _A_in["v"],
        "A_shift_k": _A_in["shift_k"],
        "A_ssm_k": _A_in["ssm_k"],
        "A_ssm_D": _A_in["ssm_D"],
        "B_x": _B_in["x"],
        "B_wqkv": _B_in["wqkv"],
        "B_wo": _B_in["wo"],
    }

def reference(A_q, A_k, A_v, A_shift_k, A_ssm_k, A_ssm_D, B_x, B_wqkv, B_wo):
    def _A_ref(q, k, v, shift_k, ssm_k, ssm_D):
        B, S, D = q.shape
        ks = shift_k.shape[-1]
        k_pad = _pad(k, ((0, 0), (ks - 1, 0), (0, 0)))
        k_shift = torch.zeros_like(k)
        for t in range(ks):
            k_shift = k_shift + k_pad[:, t:t + S, :] * shift_k[:, ks - 1 - t][None, None, :]
        kv = k_shift * v
        L = 2 * S
        kv_pad = _pad(kv, ((0, 0), (0, S), (0, 0)))
        kf_pad = _pad(ssm_k, ((0, 0), (0, S)))
        kv_f = (lambda x, axes=(-2,-1): torch.fft.rfft2(x.float(), dim=axes))(kv_pad[:, None, :, :], axes=(1, 2))
        kf_f = (lambda x, axes=(-2,-1): torch.fft.rfft2(x.float(), dim=axes))(kf_pad[:, None, :], axes=(1, 2))
        kf_f = (lambda x, *d: x.permute(*d))(kf_f, 1, 2, 0)
        y_f = kv_f * kf_f[None, :, :, :]
        y = (lambda x, s, axes=(-2,-1): torch.fft.irfft2(x, s=s, dim=axes).to(torch.bfloat16))(y_f, (1, L), axes=(1, 2))[:, 0, :S, :]
        y = y + kv * ssm_D[None, None, :]
        return q * y

    def _B_ref(x, wqkv, wo):
        B, S, D = x.shape
        H = 32; Dh = D // H
        W, dil = 8, 2
        qkv = (lambda x, *d: x.permute(*d))((x @ wqkv).reshape(B, S, 3, H, Dh), 2, 0, 3, 1, 4)
        q, k, v = qkv[0], qkv[1], qkv[2]
        scale = Dh ** -0.5
        pos = torch.arange(S)
        off = torch.arange(W) * dil
        idx = pos[:, None] - off[None, :]
        mask = idx >= 0
        idx_c = torch.where(mask, idx, 0).reshape(-1)
        kg = k[:, :, idx_c, :].reshape(B, H, S, W, Dh)
        vg = v[:, :, idx_c, :].reshape(B, H, S, W, Dh)
        logits = torch.einsum("bhsd,bhswd->bhsw", q, kg) * scale
        logits = torch.where(mask[None, None, :, :], logits, -1e9)
        attn = _softmax(logits, axis=-1)
        o = torch.einsum("bhsw,bhswd->bhsd", attn, vg)
        return (lambda x, *d: x.permute(*d))(o, 0, 2, 1, 3).reshape(B, S, D) @ wo

    a = _A_ref(A_q, A_k, A_v, A_shift_k, A_ssm_k, A_ssm_D)
    b = _B_ref(B_x, B_wqkv, B_wo)
    return torch.concatenate([a, b], axis=-1)
```

```asm
; @launch grid=(256,1,1) block=(512,1,1) lds=163840
.amdgcn_target "amdgcn-amd-amdhsa--gfx950"
.text
.globl concat_heads__ssm_conv_h3__sliding_local_dilated__prompt_kernel
.p2align 10
.fill 64, 4, 0xbf810000
.p2align 8
.type concat_heads__ssm_conv_h3__sliding_local_dilated__prompt_kernel,@function
concat_heads__ssm_conv_h3__sliding_local_dilated__prompt_kernel:
    s_cmp_ge_u32 s2, 256
    s_cbranch_scc1 L_end_m
    s_load_dwordx16 s[16:31], s[0:1], 0
    s_load_dwordx8 s[32:39], s[0:1], 64
    v_lshrrev_b32 v2, 6, v0
    v_and_b32 v1, 63, v0
    v_readfirstlane_b32 s3, v2
    s_and_b32 s4, s2, 7
    s_lshr_b32 s5, s2, 3
    s_cmp_ge_u32 s5, 27
    s_cbranch_scc1 L_roleC_m
    s_cmp_ge_u32 s5, 18
    s_cbranch_scc1 L_roleA_m
    s_lshl_b32 s6, s5, 3
    s_add_u32 s6, s6, s3
    s_cmp_lg_u32 s6, 7
    s_cbranch_scc1 L_necp_m
    s_getpc_b64 s[8:9]
L_pc0_m:
    v_lshlrev_b32 v2, 7, v1
    v_add_u32 v3, concat_heads__ssm_conv_h3__sliding_local_dilated__prompt_kernel+1024-L_pc0_m, v2
    v_add_u32 v4, L_roleA_m-5120-L_pc0_m, v2
    v_add_u32 v5, L_roleC_m-7168-L_pc0_m, v2
    v_cmp_gt_u32 vcc, 40, v1
    v_cmp_gt_u32 s[10:11], 56, v1
    v_mov_b32 v7, s9
    s_nop 0
    v_cndmask_b32 v5, v5, v4, s[10:11]
    v_cndmask_b32 v5, v5, v3, vcc
    v_add_co_u32 v6, vcc, s8, v5
    s_nop 1
    v_addc_co_u32 v7, vcc, 0, v7, vcc
    global_load_dword v250, v[6:7], off
L_necp_m:
    s_and_b32 s6, s4, 1
    s_mul_i32 s6, s6, 9
    s_lshr_b32 s8, s5, 1
    s_add_u32 s6, s6, s8
    s_and_b32 s7, s4, 6
    s_and_b32 s8, s5, 1
    s_add_u32 s7, s7, s8
    s_mul_i32 s8, s6, 114
    s_lshl_b32 s12, s7, 2
    s_and_b32 s12, s12, 4
    s_xor_b32 s12, s12, s3
    s_lshl_b32 s13, s6, 2
    s_and_b32 s13, s13, 4
    s_xor_b32 s13, s13, s3
    s_and_b32 s9, s12, 3
    s_lshl_b32 s9, s9, 5
    s_lshr_b32 s10, s12, 2
    s_add_u32 s9, s9, s10
    s_add_u32 s9, s9, s8
    v_lshrrev_b32 v33, 3, v1
    v_lshl_add_u32 v34, v33, 1, s9
    v_mul_u32_u24 v34, 1152, v34
    v_lshrrev_b32 v35, 4, v1
    v_and_b32 v36, 7, v1
    v_xor_b32 v35, v35, v36
    v_lshl_add_u32 v2, v35, 4, v34
    v_xor_b32 v3, 64, v2
    v_add_u32 v3, 18432, v3
    v_cmp_le_u32 vcc, 27, v1
    v_subrev_u32 v33, 27, v1
    v_mov_b32 v34, 13824
    v_cndmask_b32 v33, v1, v33, vcc
    v_cndmask_b32 v34, 0, v34, vcc
    v_lshl_add_u32 v34, v33, 4, v34
    v_cmp_gt_u32 vcc, 9, v33
    v_cmp_le_u32 s[10:11], 18, v33
    v_mov_b32 v35, -144
    v_mov_b32 v36, 1152
    v_cndmask_b32 v35, v35, v36, vcc
    v_mov_b32 v36, 2016
    v_cmp_le_u32 vcc, 54, v1
    v_cndmask_b32 v35, v35, v36, s[10:11]
    s_mul_i32 s10, s7, 144
    v_mov_b32 v36, 2147483648
    v_add3_u32 v4, v34, v35, s10
    v_cndmask_b32 v4, v4, v36, vcc
    s_lshl_b32 s84, s12, 11
    s_add_u32 s85, s84, 1024
    s_mul_i32 s86, s13, 4224
    s_add_u32 s86, s86, 16384
    s_add_u32 s87, s86, 1056
    s_add_u32 s88, s86, 2112
    s_add_u32 s89, s86, 3168
    s_mov_b32 s74, 0
    s_mov_b32 s75, 0
    s_mul_i32 s76, s13, 27648
    s_add_u32 s77, s76, 3456
    s_add_u32 s78, s76, 6912
    s_add_u32 s79, s76, 10368
    s_mov_b32 s80, 0
    v_and_b32 v33, 15, v1
    v_lshrrev_b32 v34, 4, v1
    v_mov_b32 v56, v34
    s_and_b32 s14, s3, 1
    s_lshr_b32 s15, s3, 1
    v_lshrrev_b32 v35, 1, v33
    v_xor_b32 v35, v35, v34
    v_lshlrev_b32 v35, 4, v35
    v_lshl_add_u32 v35, v33, 7, v35
    s_lshl_b32 s9, s14, 13
    v_add_u32 v8, s9, v35
    v_xor_b32 v9, 64, v8
    v_lshrrev_b32 v35, 2, v1
    v_mul_u32_u24 v35, 1056, v35
    v_and_b32 v36, 3, v1
    v_lshl_add_u32 v35, v36, 3, v35
    s_lshl_b32 s9, s15, 2
    s_mul_i32 s10, s15, 3
    s_add_u32 s10, s10, 2
    s_cmp_lt_u32 s15, 2
    s_cselect_b32 s70, s9, s10
    s_lshl_b32 s9, s70, 5
    s_add_u32 s10, s9, 16384
    v_add_u32 v10, s10, v35
    v_mov_b32 v12, v9
    v_mov_b32 v13, v10
    s_mul_i32 s10, s14, 22528
    s_add_u32 s10, s10, 73728
    s_add_u32 s9, s9, s10
    v_bfe_u32 v37, v1, 2, 1
    v_and_b32 v35, 31, v1
    v_mul_u32_u24 v35, 352, v35
    v_add_u32 v35, s9, v35
    s_cmp_eq_u32 s15, 2
    s_cselect_b32 s11, 1, 0
    s_cmp_lg_u32 s15, 0
    s_cselect_b32 s12, 1, 0
    s_cmp_lg_u32 s15, 0
    s_cselect_b32 s13, 2, 1
    v_cmp_gt_u32 vcc, 32, v1
    v_xor_b32 v36, s13, v37
    v_xor_b32 v38, s11, v37
    v_cndmask_b32 v38, v36, v38, vcc
    v_lshl_add_u32 v14, v38, 4, v35
    s_waitcnt lgkmcnt(0)
    s_mov_b32 s40, s28
    s_and_b32 s41, s29, 0xffff
    s_mov_b32 s42, 2359296
    s_mov_b32 s43, 0x20000
    s_mov_b32 s44, s30
    s_and_b32 s45, s31, 0xffff
    s_mov_b32 s46, 1990656
    s_mov_b32 s47, 0x20000
    s_add_u32 m0, s84, s80
    s_nop 0
    buffer_load_dwordx4 v2, s[40:43], s74 offen lds
    s_add_u32 m0, s85, s80
    s_nop 0
    buffer_load_dwordx4 v3, s[40:43], s75 offen lds
    s_add_u32 m0, s86, s80
    s_nop 0
    buffer_load_dwordx4 v4, s[44:47], s76 offen lds
    s_add_u32 m0, s87, s80
    s_nop 0
    buffer_load_dwordx4 v4, s[44:47], s77 offen lds
    s_add_u32 m0, s88, s80
    s_nop 0
    buffer_load_dwordx4 v4, s[44:47], s78 offen lds
    s_add_u32 m0, s89, s80
    s_nop 0
    buffer_load_dwordx4 v4, s[44:47], s79 offen lds
    s_add_u32 s74, s74, 128
    s_add_u32 s75, s75, 128
    s_add_u32 s76, s76, 221184
    s_add_u32 s77, s77, 221184
    s_add_u32 s78, s78, 221184
    s_add_u32 s79, s79, 221184
    s_add_u32 s80, s80, 50176
    v_xor_b32 v38, s12, v37
    v_cndmask_b32 v38, v36, v38, vcc
    v_lshl_add_u32 v54, v38, 4, v35
    s_lshl_b32 s9, s15, 5
    s_add_u32 s9, s9, s10
    v_mul_u32_u24 v35, 352, v33
    v_xor_b32 v36, v34, v37
    v_lshl_add_u32 v36, v36, 4, v35
    v_add_u32 v5, s9, v36
    v_and_b32 v35, 127, v0
    v_mul_u32_u24 v35, 352, v35
    v_xor_b32 v36, 9, v37
    v_lshl_add_u32 v35, v36, 4, v35
    v_add_u32 v55, 73728, v35
    v_mul_u32_u24 v35, 136, v33
    v_lshl_add_u32 v35, v34, 3, v35
    s_mul_i32 s9, s14, 9928
    s_add_u32 s9, s9, 118784
    s_mul_i32 s10, s70, 2176
    s_add_u32 s10, s10, s9
    s_sub_u32 s10, s10, 19584
    v_add_u32 v15, s10, v35
    v_cmp_gt_u32 vcc, 8, v33
    v_add_u32 v57, 4352, v15
    v_lshlrev_b32 v36, 3, v1
    v_add_u32 v36, 152096, v36
    v_cndmask_b32 v57, v36, v57, vcc
    s_mul_i32 s10, s15, 2448
    s_add_u32 s10, s10, s9
    v_add_u32 v6, s10, v35
    v_and_b32 v36, 2, v1
    v_cmp_eq_u32 vcc, 0, v36
    v_and_b32 v36, 1, v1
    v_mul_u32_u24 v36, 136, v36
    s_add_u32 s10, s10, 2176
    v_add_u32 v36, s10, v36
    s_add_u32 s9, s9, 9792
    v_mov_b32 v37, s9
    v_cndmask_b32 v36, v37, v36, vcc
    v_lshl_add_u32 v7, v34, 3, v36
    s_mul_i32 s9, s6, 57
    s_cmp_eq_u32 s6, 0
    s_cselect_b32 s12, 0, 7
    s_mul_i32 s10, s14, 18432
    s_lshl_b32 s11, s15, 12
    s_add_u32 s11, s11, s10
    s_lshl_b32 s13, s7, 8
    s_add_u32 s11, s11, s13
    v_and_b32 v36, 31, v1
    v_cmp_gt_u32 vcc, s12, v36
    v_add_u32 v36, s9, v36
    v_lshrrev_b32 v37, 4, v36
    v_mul_u32_u24 v37, 36864, v37
    v_and_b32 v36, 15, v36
    v_lshl_add_u32 v37, v36, 4, v37
    v_lshrrev_b32 v36, 5, v1
    v_lshl_add_u32 v37, v36, 11, v37
    v_add_u32 v21, s11, v37
    v_add_u32 v22, 73728, v21
    v_mov_b32 v38, 2147483648
    v_cndmask_b32 v21, v21, v38, vcc
    v_cmp_gt_u32 vcc, s12, v1
    v_add_u32 v36, s9, v1
    v_lshrrev_b32 v37, 4, v36
    v_mul_u32_u24 v37, 36864, v37
    v_and_b32 v36, 15, v36
    v_lshl_add_u32 v37, v36, 4, v37
    s_add_u32 s10, s10, s13
    s_lshl_b32 s11, s15, 2
    s_add_u32 s10, s10, s11
    s_add_u32 s10, s10, 16384
    v_add_u32 v23, s10, v37
    v_cndmask_b32 v23, v23, v38, vcc
    v_lshlrev_b32 v35, 2, v34
    v_subrev_u32 v36, s15, v35
    v_add_u32 v37, 0, v36
    v_add_u32 v38, 1, v36
    v_add_u32 v39, 2, v36
    v_add_u32 v40, 3, v36
    v_cmp_gt_u32 s[10:11], 9, v37
    v_cmp_gt_u32 s[12:13], 9, v38
    s_nop 0
    v_cndmask_b32 v17, 0, -1, s[10:11]
    v_cndmask_b32 v18, 0, -1, s[12:13]
    v_cmp_gt_u32 s[10:11], 9, v39
    v_cmp_gt_u32 s[12:13], 9, v40
    s_nop 0
    v_cndmask_b32 v19, 0, -1, s[10:11]
    v_cndmask_b32 v20, 0, -1, s[12:13]
    v_sub_u32 v35, v33, v35
    v_cmp_ge_i32 s[72:73], -6, v35
    v_cmp_lt_i32 s[62:63], -6, v35
    v_mov_b32 v38, 0xf149f2ca
    v_subrev_u32 v36, 0, v35
    v_and_b32 v37, 8, v36
    v_cmp_ge_u32 s[10:11], 7, v36
    v_cmp_eq_u32 vcc, 0, v37
    s_nop 0
    v_cndmask_b32 v28, v38, 0, s[10:11]
    v_cndmask_b32 v24, v38, 0, vcc
    v_subrev_u32 v36, 1, v35
    v_and_b32 v37, 8, v36
    v_cmp_ge_u32 s[10:11], 7, v36
    v_cmp_eq_u32 vcc, 0, v37
    s_nop 0
    v_cndmask_b32 v29, v38, 0, s[10:11]
    v_cndmask_b32 v25, v38, 0, vcc
    v_subrev_u32 v36, 2, v35
    v_and_b32 v37, 8, v36
    v_cmp_ge_u32 s[10:11], 7, v36
    v_cmp_eq_u32 vcc, 0, v37
    s_nop 0
    v_cndmask_b32 v30, v38, 0, s[10:11]
    v_cndmask_b32 v26, v38, 0, vcc
    v_subrev_u32 v36, 3, v35
    v_and_b32 v37, 8, v36
    v_cmp_ge_u32 s[10:11], 7, v36
    v_cmp_eq_u32 vcc, 0, v37
    s_nop 0
    v_cndmask_b32 v31, v38, 0, s[10:11]
    v_cndmask_b32 v27, v38, 0, vcc
    s_cmp_ge_u32 s5, 9
    s_cselect_b32 s9, 1, 0
    s_lshl_b32 s66, s4, 1
    s_add_u32 s66, s66, s9
    s_mul_i32 s9, s9, 9
    s_sub_u32 s67, s5, s9
    s_mul_i32 s11, s3, 82944
    s_mov_b32 s10, 0
    s_add_u32 s9, s10, 0
    s_and_b32 s9, s9, 3
    s_mul_i32 s9, s9, 20736
    s_add_u32 s24, s9, s11
    s_add_u32 s9, s10, 1
    s_and_b32 s9, s9, 3
    s_mul_i32 s9, s9, 20736
    s_add_u32 s25, s9, s11
    s_add_u32 s9, s10, 2
    s_and_b32 s9, s9, 3
    s_mul_i32 s9, s9, 20736
    s_add_u32 s26, s9, s11
    s_add_u32 s9, s10, 3
    s_and_b32 s9, s9, 3
    s_mul_i32 s9, s9, 20736
    s_add_u32 s27, s9, s11
    v_lshrrev_b32 v33, 3, v1
    v_mul_u32_u24 v33, 1152, v33
    v_bfe_u32 v34, v1, 4, 1
    v_lshlrev_b32 v34, 1, v34
    v_and_b32 v35, 7, v1
    s_add_u32 m0, s84, s80
    v_xor_b32 v34, v34, v35
    s_lshl_b32 s9, s14, 2
    v_xor_b32 v34, s9, v34
    buffer_load_dwordx4 v2, s[40:43], s74 offen lds
    s_lshl_b32 s9, s67, 7
    v_add_u32 v33, s9, v33
    v_lshl_add_u32 v16, v34, 4, v33
    s_add_u32 m0, s85, s80
    v_lshrrev_b32 v33, 4, v1
    v_mul_u32_u24 v33, 18432, v33
    v_add_u32 v33, 18432, v33
    buffer_load_dwordx4 v3, s[40:43], s75 offen lds
    v_add_u32 v32, v16, v33
    v_mov_b32 v192, 0
    v_mov_b32 v193, 0
    s_add_u32 m0, s86, s80
    v_mov_b32 v194, 0
    v_mov_b32 v195, 0
    v_mov_b32 v196, 0
    buffer_load_dwordx4 v4, s[44:47], s76 offen lds
    v_mov_b32 v197, 0
    v_mov_b32 v198, 0
    v_mov_b32 v199, 0
    s_add_u32 m0, s87, s80
    v_mov_b32 v200, 0
    v_mov_b32 v201, 0
    v_mov_b32 v202, 0
    buffer_load_dwordx4 v4, s[44:47], s77 offen lds
    v_mov_b32 v203, 0
    v_mov_b32 v204, 0
    v_mov_b32 v205, 0
    s_add_u32 m0, s88, s80
    v_mov_b32 v206, 0
    v_mov_b32 v207, 0
    v_mov_b32 v208, 0
    buffer_load_dwordx4 v4, s[44:47], s78 offen lds
    v_mov_b32 v209, 0
    v_mov_b32 v218, 0
    v_mov_b32 v219, 0
    s_add_u32 m0, s89, s80
    s_mov_b32 s90, 0x3eae1a93
    s_mov_b32 s91, 0x3eae1a93
    v_cmp_eq_u32 s[16:17], 1, v56
    buffer_load_dwordx4 v4, s[44:47], s79 offen lds
    v_cmp_eq_u32 s[18:19], 2, v56
    v_cmp_eq_u32 s[20:21], 3, v56
    s_lshl_b32 s22, s6, 3
    s_add_u32 s74, s74, 128
    s_add_u32 s75, s75, 128
    s_add_u32 s76, s76, 221184
    s_add_u32 s77, s77, 221184
    s_add_u32 s78, s78, 221184
    s_add_u32 s79, s79, 221184
    s_add_u32 s80, s80, 50176
    s_add_u32 s22, s22, s7
    s_mul_i32 s22, s22, 128
    s_mov_b32 s23, 0
    s_add_u32 s52, s38, 2359296
    s_addc_u32 s53, s39, 0
    s_and_b32 s53, s53, 0xffff
    s_mov_b32 s54, 2359296
    s_mov_b32 s55, 0x20000
    s_mov_b32 s83, 0
    s_mov_b32 s81, 0
    s_mov_b32 s82, 50176
    s_waitcnt vmcnt(6)
    s_barrier
    s_cmp_ge_u32 s3, 6
    s_cbranch_scc1 L_var2_m
    s_cmp_ge_u32 s3, 4
    s_cbranch_scc1 L_var1_m
    ds_read_b128 v[128:131], v8 offset:0
    ds_read_b128 v[132:135], v8 offset:2048
    ds_read_b128 v[136:139], v8 offset:4096
    ds_read_b128 v[140:143], v8 offset:6144
    ds_read_b64_tr_b16 v[144:145], v13 offset:0
    ds_read_b64_tr_b16 v[146:147], v13 offset:432
    ds_read_b64_tr_b16 v[148:149], v13 offset:32
    ds_read_b64_tr_b16 v[150:151], v13 offset:464
    ds_read_b64_tr_b16 v[152:153], v13 offset:64
    ds_read_b64_tr_b16 v[154:155], v13 offset:496
    ds_read_b64_tr_b16 v[156:157], v13 offset:96
    ds_read_b64_tr_b16 v[158:159], v13 offset:528
    s_waitcnt lgkmcnt(0)
    v_mfma_f32_16x16x32_bf16 v[64:67], v[144:147], v[128:131], 0
    s_add_u32 m0, s84, s80
    v_mfma_f32_16x16x32_bf16 v[68:71], v[144:147], v[132:135], 0
    ds_read_b128 v[160:163], v12 offset:0
    v_mfma_f32_16x16x32_bf16 v[72:75], v[144:147], v[136:139], 0
    ds_read_b128 v[164:167], v12 offset:2048
    v_mfma_f32_16x16x32_bf16 v[76:79], v[144:147], v[140:143], 0
    buffer_load_dwordx4 v2, s[40:43], s74 offen lds
    ds_read_b128 v[168:171], v12 offset:4096
    v_mfma_f32_16x16x32_bf16 v[80:83], v[148:151], v[128:131], 0
    ds_read_b128 v[172:175], v12 offset:6144
    v_mfma_f32_16x16x32_bf16 v[84:87], v[148:151], v[132:135], 0
    s_add_u32 m0, s85, s80
    v_mfma_f32_16x16x32_bf16 v[88:91], v[148:151], v[136:139], 0
    ds_read_b64_tr_b16 v[176:177], v13 offset:16896
    ds_read_b64_tr_b16 v[178:179], v13 offset:17328
    v_mfma_f32_16x16x32_bf16 v[92:95], v[148:151], v[140:143], 0
    buffer_load_dwordx4 v3, s[40:43], s75 offen lds
    v_mfma_f32_16x16x32_bf16 v[96:99], v[152:155], v[128:131], 0
    ds_read_b64_tr_b16 v[180:181], v13 offset:16928
    v_mfma_f32_16x16x32_bf16 v[100:103], v[152:155], v[132:135], 0
    ds_read_b64_tr_b16 v[182:183], v13 offset:17360
    s_add_u32 m0, s86, s80
    v_mfma_f32_16x16x32_bf16 v[104:107], v[152:155], v[136:139], 0
    ds_read_b64_tr_b16 v[184:185], v13 offset:16960
    v_mfma_f32_16x16x32_bf16 v[108:111], v[152:155], v[140:143], 0
    ds_read_b64_tr_b16 v[186:187], v13 offset:17392
    v_mfma_f32_16x16x32_bf16 v[112:115], v[156:159], v[128:131], 0
    buffer_load_dwordx4 v4, s[44:47], s76 offen lds
    ds_read_b64_tr_b16 v[188:189], v13 offset:16992
    v_mfma_f32_16x16x32_bf16 v[116:119], v[156:159], v[132:135], 0
    ds_read_b64_tr_b16 v[190:191], v13 offset:17424
    v_mfma_f32_16x16x32_bf16 v[120:123], v[156:159], v[136:139], 0
    v_add_u32 v11, s82, v8
    v_mfma_f32_16x16x32_bf16 v[124:127], v[156:159], v[140:143], 0
    v_add_u32 v12, s82, v9
    s_branch L_b1wait_m_0
L_b1loop_m_0:
    s_waitcnt lgkmcnt(0)
    v_mfma_f32_16x16x32_bf16 v[64:67], v[144:147], v[128:131], v[64:67]
    s_add_u32 m0, s84, s80
    v_mfma_f32_16x16x32_bf16 v[68:71], v[144:147], v[132:135], v[68:71]
    ds_read_b128 v[160:163], v12 offset:0
    v_mfma_f32_16x16x32_bf16 v[72:75], v[144:147], v[136:139], v[72:75]
    ds_read_b128 v[164:167], v12 offset:2048
    v_mfma_f32_16x16x32_bf16 v[76:79], v[144:147], v[140:143], v[76:79]
    buffer_load_dwordx4 v2, s[40:43], s74 offen lds
    ds_read_b128 v[168:171], v12 offset:4096
    v_mfma_f32_16x16x32_bf16 v[80:83], v[148:151], v[128:131], v[80:83]
    ds_read_b128 v[172:175], v12 offset:6144
    v_mfma_f32_16x16x32_bf16 v[84:87], v[148:151], v[132:135], v[84:87]
    s_add_u32 m0, s85, s80
    v_mfma_f32_16x16x32_bf16 v[88:91], v[148:151], v[136:139], v[88:91]
    ds_read_b64_tr_b16 v[176:177], v13 offset:16896
    ds_read_b64_tr_b16 v[178:179], v13 offset:17328
    v_mfma_f32_16x16x32_bf16 v[92:95], v[148:151], v[140:143], v[92:95]
    buffer_load_dwordx4 v3, s[40:43], s75 offen lds
    v_mfma_f32_16x16x32_bf16 v[96:99], v[152:155], v[128:131], v[96:99]
    ds_read_b64_tr_b16 v[180:181], v13 offset:16928
    ds_read_b64_tr_b16 v[182:183], v13 offset:17360
    v_mfma_f32_16x16x32_bf16 v[100:103], v[152:155], v[132:135], v[100:103]
    s_add_u32 m0, s86, s80
    v_mfma_f32_16x16x32_bf16 v[104:107], v[152:155], v[136:139], v[104:107]
    ds_read_b64_tr_b16 v[184:185], v13 offset:16960
    v_mfma_f32_16x16x32_bf16 v[108:111], v[152:155], v[140:143], v[108:111]
    ds_read_b64_tr_b16 v[186:187], v13 offset:17392
    buffer_load_dwordx4 v4, s[44:47], s76 offen lds
    v_mfma_f32_16x16x32_bf16 v[112:115], v[156:159], v[128:131], v[112:115]
    ds_read_b64_tr_b16 v[188:189], v13 offset:16992
    v_mfma_f32_16x16x32_bf16 v[116:119], v[156:159], v[132:135], v[116:119]
    ds_read_b64_tr_b16 v[190:191], v13 offset:17424
    s_cmp_eq_u32 s83, 8
    s_cbranch_scc1 L_b1sp8_m_0
    v_add_u32 v11, s82, v8
    v_mfma_f32_16x16x32_bf16 v[120:123], v[156:159], v[136:139], v[120:123]
    v_add_u32 v12, s82, v9
    v_mfma_f32_16x16x32_bf16 v[124:127], v[156:159], v[140:143], v[124:127]
L_b1wait_m_0:
    s_waitcnt vmcnt(3) lgkmcnt(0)
    s_barrier
    v_mfma_f32_16x16x32_bf16 v[64:67], v[176:179], v[160:163], v[64:67]
    v_add_u32 v13, s82, v10
    v_mfma_f32_16x16x32_bf16 v[68:71], v[176:179], v[164:167], v[68:71]
    s_add_u32 m0, s87, s80
    v_mfma_f32_16x16x32_bf16 v[72:75], v[176:179], v[168:171], v[72:75]
    ds_read_b128 v[128:131], v11 offset:0
    v_mfma_f32_16x16x32_bf16 v[76:79], v[176:179], v[172:175], v[76:79]
    ds_read_b128 v[132:135], v11 offset:2048
    buffer_load_dwordx4 v4, s[44:47], s77 offen lds
    v_mfma_f32_16x16x32_bf16 v[80:83], v[180:183], v[160:163], v[80:83]
    ds_read_b128 v[136:139], v11 offset:4096
    ds_read_b128 v[140:143], v11 offset:6144
    v_mfma_f32_16x16x32_bf16 v[84:87], v[180:183], v[164:167], v[84:87]
    s_add_u32 m0, s88, s80
    ds_read_b64_tr_b16 v[144:145], v13 offset:0
    v_mfma_f32_16x16x32_bf16 v[88:91], v[180:183], v[168:171], v[88:91]
    ds_read_b64_tr_b16 v[146:147], v13 offset:432
    buffer_load_dwordx4 v4, s[44:47], s78 offen lds
    v_mfma_f32_16x16x32_bf16 v[92:95], v[180:183], v[172:175], v[92:95]
    ds_read_b64_tr_b16 v[148:149], v13 offset:32
    v_mfma_f32_16x16x32_bf16 v[96:99], v[184:187], v[160:163], v[96:99]
    ds_read_b64_tr_b16 v[150:151], v13 offset:464
    s_add_u32 m0, s89, s80
    v_mfma_f32_16x16x32_bf16 v[100:103], v[184:187], v[164:167], v[100:103]
    ds_read_b64_tr_b16 v[152:153], v13 offset:64
    ds_read_b64_tr_b16 v[154:155], v13 offset:496
    v_mfma_f32_16x16x32_bf16 v[104:107], v[184:187], v[168:171], v[104:107]
    buffer_load_dwordx4 v4, s[44:47], s79 offen lds
    ds_read_b64_tr_b16 v[156:157], v13 offset:96
    v_mfma_f32_16x16x32_bf16 v[108:111], v[184:187], v[172:175], v[108:111]
    ds_read_b64_tr_b16 v[158:159], v13 offset:528
    s_cmp_ge_u32 s83, 6
    s_cbranch_scc1 L_b1sp_m_0
    s_mov_b32 s80, s81
    v_mfma_f32_16x16x32_bf16 v[112:115], v[188:191], v[160:163], v[112:115]
    s_add_u32 s74, s74, 128
    s_add_u32 s75, s75, 128
    s_add_u32 s76, s76, 221184
    v_mfma_f32_16x16x32_bf16 v[116:119], v[188:191], v[164:167], v[116:119]
    s_add_u32 s77, s77, 221184
    s_add_u32 s78, s78, 221184
    s_add_u32 s79, s79, 221184
L_b1mid_m_0:
    s_mov_b32 s81, s82
    v_mfma_f32_16x16x32_bf16 v[120:123], v[188:191], v[168:171], v[120:123]
    s_add_u32 s83, s83, 1
    v_mfma_f32_16x16x32_bf16 v[124:127], v[188:191], v[172:175], v[124:127]
    s_add_u32 s82, s82, 50176
    s_cmp_eq_u32 s82, 150528
    s_cselect_b32 s82, 0, s82
    s_branch L_b1loop_m_0
L_b1sp8_m_0:
    v_mfma_f32_16x16x32_bf16 v[120:123], v[156:159], v[136:139], v[120:123]
    s_mov_b32 exec_lo, 0x81818181
    s_mov_b32 exec_hi, 0x81818181
    buffer_load_dword v250, v21, s[52:55], 0 offen sc1
    buffer_load_dword v250, v22, s[52:55], 0 offen sc1
    buffer_load_dword v250, v23, s[52:55], 0 offen sc1
    s_mov_b64 exec, -1
    v_mfma_f32_16x16x32_bf16 v[124:127], v[156:159], v[140:143], v[124:127]
    s_waitcnt lgkmcnt(0)
    s_barrier
    v_mfma_f32_16x16x32_bf16 v[64:67], v[176:179], v[160:163], v[64:67]
    v_lshrrev_b32 v128, 5, v1
    v_mul_u32_u24 v128, 9928, v128
    v_and_b32 v129, 31, v1
    v_mfma_f32_16x16x32_bf16 v[68:71], v[176:179], v[164:167], v[68:71]
    v_lshl_add_u32 v128, v129, 2, v128
    v_add_u32 v128, 128576, v128
    v_mov_b32 v129, 0x3f803f80
    v_mfma_f32_16x16x32_bf16 v[72:75], v[176:179], v[168:171], v[72:75]
    ds_write_b32 v128, v129
    v_mfma_f32_16x16x32_bf16 v[76:79], v[176:179], v[172:175], v[76:79]
    v_cvt_pk_bf16_f32 v136, v64, v65
    v_cvt_pk_bf16_f32 v137, v66, v67
    v_mfma_f32_16x16x32_bf16 v[80:83], v[180:183], v[160:163], v[80:83]
    v_cvt_pk_bf16_f32 v138, v68, v69
    v_cvt_pk_bf16_f32 v139, v70, v71
    v_mfma_f32_16x16x32_bf16 v[84:87], v[180:183], v[164:167], v[84:87]
    v_cvt_pk_bf16_f32 v140, v72, v73
    v_cvt_pk_bf16_f32 v141, v74, v75
    v_permlane16_swap_b32 v136, v138
    v_permlane16_swap_b32 v137, v139
    ds_write_b128 v14, v[136:139] offset:0
    v_mfma_f32_16x16x32_bf16 v[88:91], v[180:183], v[168:171], v[88:91]
    v_cvt_pk_bf16_f32 v142, v76, v77
    v_cvt_pk_bf16_f32 v143, v78, v79
    v_mfma_f32_16x16x32_bf16 v[92:95], v[180:183], v[172:175], v[92:95]
    v_cvt_pk_bf16_f32 v144, v80, v81
    v_cvt_pk_bf16_f32 v145, v82, v83
    v_permlane16_swap_b32 v140, v142
    v_permlane16_swap_b32 v141, v143
    ds_write_b128 v14, v[140:143] offset:11264
    v_mfma_f32_16x16x32_bf16 v[96:99], v[184:187], v[160:163], v[96:99]
    v_cvt_pk_bf16_f32 v146, v84, v85
    v_cvt_pk_bf16_f32 v147, v86, v87
    v_mfma_f32_16x16x32_bf16 v[100:103], v[184:187], v[164:167], v[100:103]
    v_cvt_pk_bf16_f32 v148, v88, v89
    v_cvt_pk_bf16_f32 v149, v90, v91
    v_permlane16_swap_b32 v144, v146
    v_permlane16_swap_b32 v145, v147
    ds_write_b128 v54, v[144:147] offset:32
    v_mfma_f32_16x16x32_bf16 v[104:107], v[184:187], v[168:171], v[104:107]
    v_cvt_pk_bf16_f32 v150, v92, v93
    v_cvt_pk_bf16_f32 v151, v94, v95
    v_mfma_f32_16x16x32_bf16 v[108:111], v[184:187], v[172:175], v[108:111]
    v_cvt_pk_bf16_f32 v136, v96, v97
    v_cvt_pk_bf16_f32 v137, v98, v99
    v_permlane16_swap_b32 v148, v150
    v_permlane16_swap_b32 v149, v151
    ds_write_b128 v54, v[148:151] offset:11296
    v_mfma_f32_16x16x32_bf16 v[112:115], v[188:191], v[160:163], v[112:115]
    v_cvt_pk_bf16_f32 v138, v100, v101
    v_cvt_pk_bf16_f32 v139, v102, v103
    v_mfma_f32_16x16x32_bf16 v[116:119], v[188:191], v[164:167], v[116:119]
    v_cvt_pk_bf16_f32 v140, v104, v105
    v_cvt_pk_bf16_f32 v141, v106, v107
    v_permlane16_swap_b32 v136, v138
    v_permlane16_swap_b32 v137, v139
    ds_write_b128 v54, v[136:139] offset:64
    v_mfma_f32_16x16x32_bf16 v[120:123], v[188:191], v[168:171], v[120:123]
    v_cvt_pk_bf16_f32 v142, v108, v109
    v_cvt_pk_bf16_f32 v143, v110, v111
    v_mfma_f32_16x16x32_bf16 v[124:127], v[188:191], v[172:175], v[124:127]
    v_cvt_pk_bf16_f32 v144, v112, v113
    v_cvt_pk_bf16_f32 v145, v114, v115
    v_permlane16_swap_b32 v140, v142
    v_permlane16_swap_b32 v141, v143
    ds_write_b128 v54, v[140:143] offset:11328
    v_cvt_pk_bf16_f32 v146, v116, v117
    v_cvt_pk_bf16_f32 v147, v118, v119
    v_cvt_pk_bf16_f32 v148, v120, v121
    v_cvt_pk_bf16_f32 v149, v122, v123
    v_permlane16_swap_b32 v144, v146
    v_permlane16_swap_b32 v145, v147
    ds_write_b128 v54, v[144:147] offset:96
    v_cvt_pk_bf16_f32 v150, v124, v125
    v_cvt_pk_bf16_f32 v151, v126, v127
    s_nop 0
    v_permlane16_swap_b32 v148, v150
    v_permlane16_swap_b32 v149, v151
    ds_write_b128 v54, v[148:151] offset:11360
    s_branch L_attn_m
L_b1sp_m_0:
    v_mfma_f32_16x16x32_bf16 v[112:115], v[188:191], v[160:163], v[112:115]
    v_mfma_f32_16x16x32_bf16 v[116:119], v[188:191], v[164:167], v[116:119]
    s_cmp_eq_u32 s83, 7
    s_cbranch_scc1 L_b1sp7_m_0
    s_mov_b32 s40, s32
    s_and_b32 s41, s33, 0xffff
    s_mov_b32 s42, 663552
    s_mov_b32 s44, s32
    s_and_b32 s45, s33, 0xffff
    s_mov_b32 s46, 663552
    v_mov_b32 v2, v16
    v_mov_b32 v3, v16
    v_mov_b32 v4, v16
    s_mov_b32 s80, 0
    s_lshl_b32 s84, s3, 10
    s_mov_b32 s74, s24
    s_add_u32 s85, s84, 8192
    s_add_u32 s75, s24, 9216
    s_add_u32 s86, s84, 16384
    s_add_u32 s76, s25, 0
    s_add_u32 s87, s84, 24576
    s_add_u32 s77, s25, 9216
    s_add_u32 s88, s84, 32768
    s_add_u32 s78, s26, 0
    s_add_u32 s89, s84, 40960
    s_add_u32 s79, s26, 9216
    s_branch L_b1mid_m_0
L_b1sp7_m_0:
    v_mov_b32 v4, v32
    s_mov_b32 s48, s36
    s_and_b32 s49, s37, 0xffff
    s_mov_b32 s50, 256
    s_mov_b32 s51, 0x20000
    v_mov_b32 v241, 0
    buffer_load_dwordx2 v[242:243], v241, s[48:51], 0 offen sc1
    s_add_u32 s84, s84, 49152
    s_add_u32 s74, s27, 0
    s_add_u32 s85, s85, 49152
    s_add_u32 s75, s27, 9216
    s_add_u32 s86, s86, 49152
    s_mul_i32 s76, s3, 82944
    s_branch L_b1mid_m_0
L_var1_m:
    ds_read_b128 v[128:131], v8 offset:0
    ds_read_b128 v[132:135], v8 offset:2048
    ds_read_b128 v[136:139], v8 offset:4096
    ds_read_b128 v[140:143], v8 offset:6144
    ds_read_b64_tr_b16 v[144:145], v13 offset:0
    ds_read_b64_tr_b16 v[146:147], v13 offset:432
    ds_read_b64_tr_b16 v[148:149], v13 offset:32
    ds_read_b64_tr_b16 v[150:151], v13 offset:464
    ds_read_b64_tr_b16 v[152:153], v13 offset:64
    ds_read_b64_tr_b16 v[154:155], v13 offset:496
    s_waitcnt lgkmcnt(0)
    v_mfma_f32_16x16x32_bf16 v[64:67], v[144:147], v[128:131], 0
    s_add_u32 m0, s84, s80
    v_mfma_f32_16x16x32_bf16 v[68:71], v[144:147], v[132:135], 0
    ds_read_b128 v[160:163], v12 offset:0
    v_mfma_f32_16x16x32_bf16 v[72:75], v[144:147], v[136:139], 0
    ds_read_b128 v[164:167], v12 offset:2048
    buffer_load_dwordx4 v2, s[40:43], s74 offen lds
    v_mfma_f32_16x16x32_bf16 v[76:79], v[144:147], v[140:143], 0
    ds_read_b128 v[168:171], v12 offset:4096
    v_mfma_f32_16x16x32_bf16 v[80:83], v[128:131], v[148:151], 0
    ds_read_b128 v[172:175], v12 offset:6144
    s_add_u32 m0, s85, s80
    v_mfma_f32_16x16x32_bf16 v[84:87], v[132:135], v[148:151], 0
    ds_read_b64_tr_b16 v[176:177], v13 offset:16896
    buffer_load_dwordx4 v3, s[40:43], s75 offen lds
    v_mfma_f32_16x16x32_bf16 v[88:91], v[136:139], v[148:151], 0
    ds_read_b64_tr_b16 v[178:179], v13 offset:17328
    v_mfma_f32_16x16x32_bf16 v[92:95], v[140:143], v[148:151], 0
    ds_read_b64_tr_b16 v[180:181], v13 offset:16928
    s_add_u32 m0, s86, s80
    v_mfma_f32_16x16x32_bf16 v[96:99], v[128:131], v[152:155], 0
    ds_read_b64_tr_b16 v[182:183], v13 offset:17360
    ds_read_b64_tr_b16 v[184:185], v13 offset:16960
    v_mfma_f32_16x16x32_bf16 v[100:103], v[132:135], v[152:155], 0
    buffer_load_dwordx4 v4, s[44:47], s76 offen lds
    v_mfma_f32_16x16x32_bf16 v[104:107], v[136:139], v[152:155], 0
    ds_read_b64_tr_b16 v[186:187], v13 offset:17392
    v_add_u32 v11, s82, v8
    v_mfma_f32_16x16x32_bf16 v[108:111], v[140:143], v[152:155], 0
    v_add_u32 v12, s82, v9
    s_branch L_b1wait_m_1
L_b1loop_m_1:
    s_waitcnt lgkmcnt(0)
    v_mfma_f32_16x16x32_bf16 v[64:67], v[144:147], v[128:131], v[64:67]
    s_add_u32 m0, s84, s80
    s_setprio 0
    v_mfma_f32_16x16x32_bf16 v[68:71], v[144:147], v[132:135], v[68:71]
    ds_read_b128 v[160:163], v12 offset:0
    v_mfma_f32_16x16x32_bf16 v[72:75], v[144:147], v[136:139], v[72:75]
    ds_read_b128 v[164:167], v12 offset:2048
    buffer_load_dwordx4 v2, s[40:43], s74 offen lds
    v_mfma_f32_16x16x32_bf16 v[76:79], v[144:147], v[140:143], v[76:79]
    ds_read_b128 v[168:171], v12 offset:4096
    ds_read_b128 v[172:175], v12 offset:6144
    v_mfma_f32_16x16x32_bf16 v[80:83], v[128:131], v[148:151], v[80:83]
    s_add_u32 m0, s85, s80
    ds_read_b64_tr_b16 v[176:177], v13 offset:16896
    v_mfma_f32_16x16x32_bf16 v[84:87], v[132:135], v[148:151], v[84:87]
    buffer_load_dwordx4 v3, s[40:43], s75 offen lds
    v_mfma_f32_16x16x32_bf16 v[88:91], v[136:139], v[148:151], v[88:91]
    ds_read_b64_tr_b16 v[178:179], v13 offset:17328
    ds_read_b64_tr_b16 v[180:181], v13 offset:16928
    v_mfma_f32_16x16x32_bf16 v[92:95], v[140:143], v[148:151], v[92:95]
    s_add_u32 m0, s86, s80
    ds_read_b64_tr_b16 v[182:183], v13 offset:17360
    v_mfma_f32_16x16x32_bf16 v[96:99], v[128:131], v[152:155], v[96:99]
    ds_read_b64_tr_b16 v[184:185], v13 offset:16960
    buffer_load_dwordx4 v4, s[44:47], s76 offen lds
    v_mfma_f32_16x16x32_bf16 v[100:103], v[132:135], v[152:155], v[100:103]
    ds_read_b64_tr_b16 v[186:187], v13 offset:17392
    s_cmp_eq_u32 s83, 8
    s_cbranch_scc1 L_b1sp8_m_1
    v_add_u32 v11, s82, v8
    v_mfma_f32_16x16x32_bf16 v[104:107], v[136:139], v[152:155], v[104:107]
    v_add_u32 v12, s82, v9
    v_mfma_f32_16x16x32_bf16 v[108:111], v[140:143], v[152:155], v[108:111]
L_b1wait_m_1:
    s_waitcnt vmcnt(3) lgkmcnt(0)
    s_barrier
    s_setprio 1
    v_mfma_f32_16x16x32_bf16 v[64:67], v[176:179], v[160:163], v[64:67]
    v_add_u32 v13, s82, v10
    v_mfma_f32_16x16x32_bf16 v[68:71], v[176:179], v[164:167], v[68:71]
    s_add_u32 m0, s87, s80
    v_mfma_f32_16x16x32_bf16 v[72:75], v[176:179], v[168:171], v[72:75]
    ds_read_b128 v[128:131], v11 offset:0
    ds_read_b128 v[132:135], v11 offset:2048
    v_mfma_f32_16x16x32_bf16 v[76:79], v[176:179], v[172:175], v[76:79]
    buffer_load_dwordx4 v4, s[44:47], s77 offen lds
    ds_read_b128 v[136:139], v11 offset:4096
    ds_read_b128 v[140:143], v11 offset:6144
    v_mfma_f32_16x16x32_bf16 v[80:83], v[160:163], v[180:183], v[80:83]
    s_add_u32 m0, s88, s80
    ds_read_b64_tr_b16 v[144:145], v13 offset:0
    buffer_load_dwordx4 v4, s[44:47], s78 offen lds
    v_mfma_f32_16x16x32_bf16 v[84:87], v[164:167], v[180:183], v[84:87]
    ds_read_b64_tr_b16 v[146:147], v13 offset:432
    ds_read_b64_tr_b16 v[148:149], v13 offset:32
    v_mfma_f32_16x16x32_bf16 v[88:91], v[168:171], v[180:183], v[88:91]
    s_add_u32 m0, s89, s80
    ds_read_b64_tr_b16 v[150:151], v13 offset:464
    ds_read_b64_tr_b16 v[152:153], v13 offset:64
    v_mfma_f32_16x16x32_bf16 v[92:95], v[172:175], v[180:183], v[92:95]
    buffer_load_dwordx4 v4, s[44:47], s79 offen lds
    ds_read_b64_tr_b16 v[154:155], v13 offset:496
    s_cmp_ge_u32 s83, 6
    s_cbranch_scc1 L_b1sp_m_1
    s_mov_b32 s80, s81
    v_mfma_f32_16x16x32_bf16 v[96:99], v[160:163], v[184:187], v[96:99]
    s_add_u32 s74, s74, 128
    s_add_u32 s75, s75, 128
    s_add_u32 s76, s76, 221184
    v_mfma_f32_16x16x32_bf16 v[100:103], v[164:167], v[184:187], v[100:103]
    s_add_u32 s77, s77, 221184
    s_add_u32 s78, s78, 221184
    s_add_u32 s79, s79, 221184
L_b1mid_m_1:
    s_mov_b32 s81, s82
    v_mfma_f32_16x16x32_bf16 v[104:107], v[168:171], v[184:187], v[104:107]
    s_add_u32 s83, s83, 1
    v_mfma_f32_16x16x32_bf16 v[108:111], v[172:175], v[184:187], v[108:111]
    s_add_u32 s82, s82, 50176
    s_cmp_eq_u32 s82, 150528
    s_cselect_b32 s82, 0, s82
    s_branch L_b1loop_m_1
L_b1sp8_m_1:
    v_mfma_f32_16x16x32_bf16 v[104:107], v[136:139], v[152:155], v[104:107]
    s_mov_b32 exec_lo, 0x81818181
    s_mov_b32 exec_hi, 0x81818181
    buffer_load_dword v250, v21, s[52:55], 0 offen sc1
    buffer_load_dword v250, v22, s[52:55], 0 offen sc1
    buffer_load_dword v250, v23, s[52:55], 0 offen sc1
    s_mov_b64 exec, -1
    v_mfma_f32_16x16x32_bf16 v[108:111], v[140:143], v[152:155], v[108:111]
    s_waitcnt lgkmcnt(0)
    s_barrier
    v_mfma_f32_16x16x32_bf16 v[64:67], v[176:179], v[160:163], v[64:67]
    v_mfma_f32_16x16x32_bf16 v[68:71], v[176:179], v[164:167], v[68:71]
    v_mfma_f32_16x16x32_bf16 v[72:75], v[176:179], v[168:171], v[72:75]
    v_mfma_f32_16x16x32_bf16 v[76:79], v[176:179], v[172:175], v[76:79]
    s_nop 4
    v_cvt_pk_bf16_f32 v136, v64, v65
    v_cvt_pk_bf16_f32 v137, v66, v67
    v_mfma_f32_16x16x32_bf16 v[80:83], v[160:163], v[180:183], v[80:83]
    v_cvt_pk_bf16_f32 v138, v68, v69
    v_cvt_pk_bf16_f32 v139, v70, v71
    v_mfma_f32_16x16x32_bf16 v[84:87], v[164:167], v[180:183], v[84:87]
    v_cvt_pk_bf16_f32 v140, v72, v73
    v_cvt_pk_bf16_f32 v141, v74, v75
    v_permlane16_swap_b32 v136, v138
    v_permlane16_swap_b32 v137, v139
    ds_write_b128 v14, v[136:139] offset:0
    v_mfma_f32_16x16x32_bf16 v[88:91], v[168:171], v[180:183], v[88:91]
    v_cvt_pk_bf16_f32 v142, v76, v77
    v_cvt_pk_bf16_f32 v143, v78, v79
    v_mfma_f32_16x16x32_bf16 v[92:95], v[172:175], v[180:183], v[92:95]
    v_cvt_pk_bf16_f32 v144, v80, v81
    v_cvt_pk_bf16_f32 v145, v82, v83
    ds_write_b64 v15, v[144:145] offset:2176
    v_permlane16_swap_b32 v140, v142
    v_permlane16_swap_b32 v141, v143
    ds_write_b128 v14, v[140:143] offset:11264
    v_mfma_f32_16x16x32_bf16 v[96:99], v[160:163], v[184:187], v[96:99]
    v_cvt_pk_bf16_f32 v146, v84, v85
    v_cvt_pk_bf16_f32 v147, v86, v87
    ds_write_b64 v15, v[146:147] offset:2208
    v_mfma_f32_16x16x32_bf16 v[100:103], v[164:167], v[184:187], v[100:103]
    v_cvt_pk_bf16_f32 v148, v88, v89
    v_cvt_pk_bf16_f32 v149, v90, v91
    ds_write_b64 v15, v[148:149] offset:2240
    v_mfma_f32_16x16x32_bf16 v[104:107], v[168:171], v[184:187], v[104:107]
    v_cvt_pk_bf16_f32 v150, v92, v93
    v_cvt_pk_bf16_f32 v151, v94, v95
    ds_write_b64 v15, v[150:151] offset:2272
    v_mfma_f32_16x16x32_bf16 v[108:111], v[172:175], v[184:187], v[108:111]
    v_cvt_pk_bf16_f32 v136, v96, v97
    v_cvt_pk_bf16_f32 v137, v98, v99
    ds_write_b64 v15, v[136:137] offset:4352
    v_cvt_pk_bf16_f32 v138, v100, v101
    v_cvt_pk_bf16_f32 v139, v102, v103
    ds_write_b64 v15, v[138:139] offset:4384
    v_cvt_pk_bf16_f32 v140, v104, v105
    v_cvt_pk_bf16_f32 v141, v106, v107
    ds_write_b64 v15, v[140:141] offset:4416
    v_cvt_pk_bf16_f32 v142, v108, v109
    v_cvt_pk_bf16_f32 v143, v110, v111
    ds_write_b64 v15, v[142:143] offset:4448
    s_branch L_attn_m
L_b1sp_m_1:
    v_mfma_f32_16x16x32_bf16 v[96:99], v[160:163], v[184:187], v[96:99]
    v_mfma_f32_16x16x32_bf16 v[100:103], v[164:167], v[184:187], v[100:103]
    s_cmp_eq_u32 s83, 7
    s_cbranch_scc1 L_b1sp7_m_1
    s_mov_b32 s40, s32
    s_and_b32 s41, s33, 0xffff
    s_mov_b32 s42, 663552
    s_mov_b32 s44, s32
    s_and_b32 s45, s33, 0xffff
    s_mov_b32 s46, 663552
    v_mov_b32 v2, v16
    v_mov_b32 v3, v16
    v_mov_b32 v4, v16
    s_mov_b32 s80, 0
    s_lshl_b32 s84, s3, 10
    s_mov_b32 s74, s24
    s_add_u32 s85, s84, 8192
    s_add_u32 s75, s24, 9216
    s_add_u32 s86, s84, 16384
    s_add_u32 s76, s25, 0
    s_add_u32 s87, s84, 24576
    s_add_u32 s77, s25, 9216
    s_add_u32 s88, s84, 32768
    s_add_u32 s78, s26, 0
    s_add_u32 s89, s84, 40960
    s_add_u32 s79, s26, 9216
    s_branch L_b1mid_m_1
L_b1sp7_m_1:
    v_mov_b32 v4, v32
    s_mov_b32 s48, s36
    s_and_b32 s49, s37, 0xffff
    s_mov_b32 s50, 256
    s_mov_b32 s51, 0x20000
    v_mov_b32 v241, 0
    buffer_load_dwordx2 v[242:243], v241, s[48:51], 0 offen sc1
    s_add_u32 s84, s84, 49152
    s_add_u32 s74, s27, 0
    s_add_u32 s85, s85, 49152
    s_add_u32 s75, s27, 9216
    s_add_u32 s86, s86, 49152
    s_mul_i32 s76, s3, 82944
    s_branch L_b1mid_m_1
L_var2_m:
    ds_read_b128 v[128:131], v8 offset:0
    ds_read_b128 v[132:135], v8 offset:2048
    ds_read_b128 v[136:139], v8 offset:4096
    ds_read_b128 v[140:143], v8 offset:6144
    ds_read_b64_tr_b16 v[144:145], v13 offset:0
    ds_read_b64_tr_b16 v[146:147], v13 offset:432
    ds_read_b64_tr_b16 v[148:149], v13 offset:32
    ds_read_b64_tr_b16 v[150:151], v13 offset:464
    ds_read_b64_tr_b16 v[152:153], v13 offset:64
    ds_read_b64_tr_b16 v[154:155], v13 offset:496
    s_waitcnt lgkmcnt(0)
    v_mfma_f32_16x16x32_bf16 v[64:67], v[128:131], v[144:147], 0
    s_add_u32 m0, s84, s80
    v_mfma_f32_16x16x32_bf16 v[68:71], v[132:135], v[144:147], 0
    ds_read_b128 v[160:163], v12 offset:0
    v_mfma_f32_16x16x32_bf16 v[72:75], v[136:139], v[144:147], 0
    ds_read_b128 v[164:167], v12 offset:2048
    buffer_load_dwordx4 v2, s[40:43], s74 offen lds
    v_mfma_f32_16x16x32_bf16 v[76:79], v[140:143], v[144:147], 0
    ds_read_b128 v[168:171], v12 offset:4096
    v_mfma_f32_16x16x32_bf16 v[80:83], v[128:131], v[148:151], 0
    ds_read_b128 v[172:175], v12 offset:6144
    s_add_u32 m0, s85, s80
    v_mfma_f32_16x16x32_bf16 v[84:87], v[132:135], v[148:151], 0
    ds_read_b64_tr_b16 v[176:177], v13 offset:16896
    buffer_load_dwordx4 v3, s[40:43], s75 offen lds
    v_mfma_f32_16x16x32_bf16 v[88:91], v[136:139], v[148:151], 0
    ds_read_b64_tr_b16 v[178:179], v13 offset:17328
    v_mfma_f32_16x16x32_bf16 v[92:95], v[140:143], v[148:151], 0
    ds_read_b64_tr_b16 v[180:181], v13 offset:16928
    s_add_u32 m0, s86, s80
    v_mfma_f32_16x16x32_bf16 v[96:99], v[128:131], v[152:155], 0
    ds_read_b64_tr_b16 v[182:183], v13 offset:17360
    ds_read_b64_tr_b16 v[184:185], v13 offset:16960
    v_mfma_f32_16x16x32_bf16 v[100:103], v[132:135], v[152:155], 0
    buffer_load_dwordx4 v4, s[44:47], s76 offen lds
    v_mfma_f32_16x16x32_bf16 v[104:107], v[136:139], v[152:155], 0
    ds_read_b64_tr_b16 v[186:187], v13 offset:17392
    v_add_u32 v11, s82, v8
    v_mfma_f32_16x16x32_bf16 v[108:111], v[140:143], v[152:155], 0
    v_add_u32 v12, s82, v9
    s_branch L_b1wait_m_2
L_b1loop_m_2:
    s_waitcnt lgkmcnt(0)
    v_mfma_f32_16x16x32_bf16 v[64:67], v[128:131], v[144:147], v[64:67]
    s_add_u32 m0, s84, s80
    s_setprio 0
    v_mfma_f32_16x16x32_bf16 v[68:71], v[132:135], v[144:147], v[68:71]
    ds_read_b128 v[160:163], v12 offset:0
    v_mfma_f32_16x16x32_bf16 v[72:75], v[136:139], v[144:147], v[72:75]
    ds_read_b128 v[164:167], v12 offset:2048
    buffer_load_dwordx4 v2, s[40:43], s74 offen lds
    v_mfma_f32_16x16x32_bf16 v[76:79], v[140:143], v[144:147], v[76:79]
    ds_read_b128 v[168:171], v12 offset:4096
    ds_read_b128 v[172:175], v12 offset:6144
    v_mfma_f32_16x16x32_bf16 v[80:83], v[128:131], v[148:151], v[80:83]
    s_add_u32 m0, s85, s80
    ds_read_b64_tr_b16 v[176:177], v13 offset:16896
    v_mfma_f32_16x16x32_bf16 v[84:87], v[132:135], v[148:151], v[84:87]
    buffer_load_dwordx4 v3, s[40:43], s75 offen lds
    v_mfma_f32_16x16x32_bf16 v[88:91], v[136:139], v[148:151], v[88:91]
    ds_read_b64_tr_b16 v[178:179], v13 offset:17328
    ds_read_b64_tr_b16 v[180:181], v13 offset:16928
    v_mfma_f32_16x16x32_bf16 v[92:95], v[140:143], v[148:151], v[92:95]
    s_add_u32 m0, s86, s80
    ds_read_b64_tr_b16 v[182:183], v13 offset:17360
    v_mfma_f32_16x16x32_bf16 v[96:99], v[128:131], v[152:155], v[96:99]
    ds_read_b64_tr_b16 v[184:185], v13 offset:16960
    buffer_load_dwordx4 v4, s[44:47], s76 offen lds
    v_mfma_f32_16x16x32_bf16 v[100:103], v[132:135], v[152:155], v[100:103]
    ds_read_b64_tr_b16 v[186:187], v13 offset:17392
    s_cmp_eq_u32 s83, 8
    s_cbranch_scc1 L_b1sp8_m_2
    v_add_u32 v11, s82, v8
    v_mfma_f32_16x16x32_bf16 v[104:107], v[136:139], v[152:155], v[104:107]
    v_add_u32 v12, s82, v9
    v_mfma_f32_16x16x32_bf16 v[108:111], v[140:143], v[152:155], v[108:111]
L_b1wait_m_2:
    s_waitcnt vmcnt(3) lgkmcnt(0)
    s_barrier
    s_setprio 1
    v_mfma_f32_16x16x32_bf16 v[64:67], v[160:163], v[176:179], v[64:67]
    v_add_u32 v13, s82, v10
    v_mfma_f32_16x16x32_bf16 v[68:71], v[164:167], v[176:179], v[68:71]
    s_add_u32 m0, s87, s80
    v_mfma_f32_16x16x32_bf16 v[72:75], v[168:171], v[176:179], v[72:75]
    ds_read_b128 v[128:131], v11 offset:0
    ds_read_b128 v[132:135], v11 offset:2048
    v_mfma_f32_16x16x32_bf16 v[76:79], v[172:175], v[176:179], v[76:79]
    buffer_load_dwordx4 v4, s[44:47], s77 offen lds
    ds_read_b128 v[136:139], v11 offset:4096
    ds_read_b128 v[140:143], v11 offset:6144
    v_mfma_f32_16x16x32_bf16 v[80:83], v[160:163], v[180:183], v[80:83]
    s_add_u32 m0, s88, s80
    ds_read_b64_tr_b16 v[144:145], v13 offset:0
    buffer_load_dwordx4 v4, s[44:47], s78 offen lds
    v_mfma_f32_16x16x32_bf16 v[84:87], v[164:167], v[180:183], v[84:87]
    ds_read_b64_tr_b16 v[146:147], v13 offset:432
    ds_read_b64_tr_b16 v[148:149], v13 offset:32
    v_mfma_f32_16x16x32_bf16 v[88:91], v[168:171], v[180:183], v[88:91]
    s_add_u32 m0, s89, s80
    ds_read_b64_tr_b16 v[150:151], v13 offset:464
    ds_read_b64_tr_b16 v[152:153], v13 offset:64
    v_mfma_f32_16x16x32_bf16 v[92:95], v[172:175], v[180:183], v[92:95]
    buffer_load_dwordx4 v4, s[44:47], s79 offen lds
    ds_read_b64_tr_b16 v[154:155], v13 offset:496
    s_cmp_ge_u32 s83, 6
    s_cbranch_scc1 L_b1sp_m_2
    s_mov_b32 s80, s81
    v_mfma_f32_16x16x32_bf16 v[96:99], v[160:163], v[184:187], v[96:99]
    s_add_u32 s74, s74, 128
    s_add_u32 s75, s75, 128
    s_add_u32 s76, s76, 221184
    v_mfma_f32_16x16x32_bf16 v[100:103], v[164:167], v[184:187], v[100:103]
    s_add_u32 s77, s77, 221184
    s_add_u32 s78, s78, 221184
    s_add_u32 s79, s79, 221184
L_b1mid_m_2:
    s_mov_b32 s81, s82
    v_mfma_f32_16x16x32_bf16 v[104:107], v[168:171], v[184:187], v[104:107]
    s_add_u32 s83, s83, 1
    v_mfma_f32_16x16x32_bf16 v[108:111], v[172:175], v[184:187], v[108:111]
    s_add_u32 s82, s82, 50176
    s_cmp_eq_u32 s82, 150528
    s_cselect_b32 s82, 0, s82
    s_branch L_b1loop_m_2
L_b1sp8_m_2:
    v_mfma_f32_16x16x32_bf16 v[104:107], v[136:139], v[152:155], v[104:107]
    s_mov_b32 exec_lo, 0x81818181
    s_mov_b32 exec_hi, 0x81818181
    buffer_load_dword v250, v21, s[52:55], 0 offen sc1
    buffer_load_dword v250, v22, s[52:55], 0 offen sc1
    buffer_load_dword v250, v23, s[52:55], 0 offen sc1
    s_mov_b64 exec, -1
    v_mfma_f32_16x16x32_bf16 v[108:111], v[140:143], v[152:155], v[108:111]
    s_waitcnt lgkmcnt(0)
    s_barrier
    v_mfma_f32_16x16x32_bf16 v[64:67], v[160:163], v[176:179], v[64:67]
    v_mov_b32 v128, 0
    v_mov_b32 v129, 0
    v_mov_b32 v130, 0
    v_mfma_f32_16x16x32_bf16 v[68:71], v[164:167], v[176:179], v[68:71]
    v_mov_b32 v131, 0
    ds_write_b128 v55, v[128:131]
    v_mfma_f32_16x16x32_bf16 v[72:75], v[168:171], v[176:179], v[72:75]
    v_mfma_f32_16x16x32_bf16 v[76:79], v[172:175], v[176:179], v[76:79]
    v_cvt_pk_bf16_f32 v136, v64, v65
    v_cvt_pk_bf16_f32 v137, v66, v67
    ds_write_b64 v15, v[136:137] offset:0
    v_mfma_f32_16x16x32_bf16 v[80:83], v[160:163], v[180:183], v[80:83]
    v_cvt_pk_bf16_f32 v138, v68, v69
    v_cvt_pk_bf16_f32 v139, v70, v71
    ds_write_b64 v15, v[138:139] offset:32
    v_mfma_f32_16x16x32_bf16 v[84:87], v[164:167], v[180:183], v[84:87]
    v_cvt_pk_bf16_f32 v140, v72, v73
    v_cvt_pk_bf16_f32 v141, v74, v75
    ds_write_b64 v15, v[140:141] offset:64
    v_mfma_f32_16x16x32_bf16 v[88:91], v[168:171], v[180:183], v[88:91]
    v_cvt_pk_bf16_f32 v142, v76, v77
    v_cvt_pk_bf16_f32 v143, v78, v79
    ds_write_b64 v15, v[142:143] offset:96
    v_mfma_f32_16x16x32_bf16 v[92:95], v[172:175], v[180:183], v[92:95]
    v_cvt_pk_bf16_f32 v144, v80, v81
    v_cvt_pk_bf16_f32 v145, v82, v83
    ds_write_b64 v15, v[144:145] offset:2176
    v_mfma_f32_16x16x32_bf16 v[96:99], v[160:163], v[184:187], v[96:99]
    v_cvt_pk_bf16_f32 v146, v84, v85
    v_cvt_pk_bf16_f32 v147, v86, v87
    ds_write_b64 v15, v[146:147] offset:2208
    v_mfma_f32_16x16x32_bf16 v[100:103], v[164:167], v[184:187], v[100:103]
    v_cvt_pk_bf16_f32 v148, v88, v89
    v_cvt_pk_bf16_f32 v149, v90, v91
    ds_write_b64 v15, v[148:149] offset:2240
    v_mfma_f32_16x16x32_bf16 v[104:107], v[168:171], v[184:187], v[104:107]
    v_cvt_pk_bf16_f32 v150, v92, v93
    v_cvt_pk_bf16_f32 v151, v94, v95
    ds_write_b64 v15, v[150:151] offset:2272
    v_mfma_f32_16x16x32_bf16 v[108:111], v[172:175], v[184:187], v[108:111]
    v_cvt_pk_bf16_f32 v136, v96, v97
    v_cvt_pk_bf16_f32 v137, v98, v99
    ds_write_b64 v57, v[136:137] offset:0
    v_cvt_pk_bf16_f32 v138, v100, v101
    v_cvt_pk_bf16_f32 v139, v102, v103
    ds_write_b64 v57, v[138:139] offset:32
    v_cvt_pk_bf16_f32 v140, v104, v105
    v_cvt_pk_bf16_f32 v141, v106, v107
    ds_write_b64 v57, v[140:141] offset:64
    v_cvt_pk_bf16_f32 v142, v108, v109
    v_cvt_pk_bf16_f32 v143, v110, v111
    ds_write_b64 v57, v[142:143] offset:96
    s_branch L_attn_m
L_b1sp_m_2:
    v_mfma_f32_16x16x32_bf16 v[96:99], v[160:163], v[184:187], v[96:99]
    v_mfma_f32_16x16x32_bf16 v[100:103], v[164:167], v[184:187], v[100:103]
    s_cmp_eq_u32 s83, 7
    s_cbranch_scc1 L_b1sp7_m_2
    s_mov_b32 s40, s32
    s_and_b32 s41, s33, 0xffff
    s_mov_b32 s42, 663552
    s_mov_b32 s44, s32
    s_and_b32 s45, s33, 0xffff
    s_mov_b32 s46, 663552
    v_mov_b32 v2, v16
    v_mov_b32 v3, v16
    v_mov_b32 v4, v16
    s_mov_b32 s80, 0
    s_lshl_b32 s84, s3, 10
    s_mov_b32 s74, s24
    s_add_u32 s85, s84, 8192
    s_add_u32 s75, s24, 9216
    s_add_u32 s86, s84, 16384
    s_add_u32 s76, s25, 0
    s_add_u32 s87, s84, 24576
    s_add_u32 s77, s25, 9216
    s_add_u32 s88, s84, 32768
    s_add_u32 s78, s26, 0
    s_add_u32 s89, s84, 40960
    s_add_u32 s79, s26, 9216
    s_branch L_b1mid_m_2
L_b1sp7_m_2:
    v_mov_b32 v4, v32
    s_mov_b32 s48, s36
    s_and_b32 s49, s37, 0xffff
    s_mov_b32 s50, 256
    s_mov_b32 s51, 0x20000
    v_mov_b32 v241, 0
    buffer_load_dwordx2 v[242:243], v241, s[48:51], 0 offen sc1
    s_add_u32 s84, s84, 49152
    s_add_u32 s74, s27, 0
    s_add_u32 s85, s85, 49152
    s_add_u32 s75, s27, 9216
    s_add_u32 s86, s86, 49152
    s_mul_i32 s76, s3, 82944
    s_branch L_b1mid_m_2
L_attn_m:
    s_setprio 0
    s_waitcnt vmcnt(3) lgkmcnt(0)
    s_barrier
    ds_read_b128 v[80:83], v5 offset:160
    ds_read_b128 v[64:67], v5 offset:0
    ds_read_b128 v[84:87], v5 offset:5792
    ds_read_b128 v[68:71], v5 offset:5632
    ds_read_b128 v[88:91], v5 offset:11424
    ds_read_b128 v[72:75], v5 offset:11264
    ds_read_b128 v[92:95], v5 offset:17056
    ds_read_b128 v[76:79], v5 offset:16896
    ds_read_b64 v[210:211], v6 offset:0
    ds_read_b64 v[220:221], v7 offset:0
    ds_read_b64 v[212:213], v6 offset:32
    ds_read_b64 v[222:223], v7 offset:32
    ds_read_b64 v[214:215], v6 offset:64
    ds_read_b64 v[224:225], v7 offset:64
    ds_read_b64 v[216:217], v6 offset:96
    ds_read_b64 v[226:227], v7 offset:96
    s_waitcnt lgkmcnt(15)
    v_and_b32 v80, v80, v17
    v_and_b32 v81, v81, v18
    v_and_b32 v82, v82, v19
    v_and_b32 v83, v83, v20
    s_waitcnt lgkmcnt(13)
    v_and_b32 v84, v84, v17
    v_and_b32 v85, v85, v18
    v_and_b32 v86, v86, v19
    v_and_b32 v87, v87, v20
    s_waitcnt lgkmcnt(11)
    v_and_b32 v88, v88, v17
    v_and_b32 v89, v89, v18
    v_and_b32 v90, v90, v19
    v_and_b32 v91, v91, v20
    s_waitcnt lgkmcnt(9)
    v_and_b32 v92, v92, v17
    v_and_b32 v93, v93, v18
    v_and_b32 v94, v94, v19
    v_and_b32 v95, v95, v20
    s_waitcnt lgkmcnt(8)
    v_mfma_f32_16x16x32_bf16 v[116:119], v[64:67], v[80:83], 0
    v_mfma_f32_16x16x32_bf16 v[120:123], v[68:71], v[84:87], 0
    v_mfma_f32_16x16x32_bf16 v[136:139], v[64:67], v[84:87], 0
    v_mfma_f32_16x16x32_bf16 v[124:127], v[72:75], v[88:91], 0
    v_mfma_f32_16x16x32_bf16 v[140:143], v[68:71], v[88:91], 0
    v_mfma_f32_16x16x32_bf16 v[128:131], v[76:79], v[92:95], 0
    v_mfma_f32_16x16x32_bf16 v[144:147], v[72:75], v[92:95], 0
    s_nop 1
    v_pk_fma_f32 v[116:117], v[116:117], s[90:91], v[28:29]
    v_pk_fma_f32 v[118:119], v[118:119], s[90:91], v[30:31]
    v_max3_f32 v148, v116, v117, v118
    v_max_f32 v148, v148, v119
    s_mov_b64 exec, s[62:63]
    v_pk_fma_f32 v[120:121], v[120:121], s[90:91], v[24:25]
    v_pk_fma_f32 v[122:123], v[122:123], s[90:91], v[26:27]
    v_pk_fma_f32 v[124:125], v[124:125], s[90:91], v[24:25]
    v_pk_fma_f32 v[126:127], v[126:127], s[90:91], v[26:27]
    v_pk_fma_f32 v[128:129], v[128:129], s[90:91], v[24:25]
    v_pk_fma_f32 v[130:131], v[130:131], s[90:91], v[26:27]
    s_mov_b64 exec, s[72:73]
    v_pk_fma_f32 v[120:121], v[136:137], s[90:91], v[24:25]
    v_pk_fma_f32 v[122:123], v[138:139], s[90:91], v[26:27]
    v_pk_fma_f32 v[124:125], v[140:141], s[90:91], v[24:25]
    v_pk_fma_f32 v[126:127], v[142:143], s[90:91], v[26:27]
    v_pk_fma_f32 v[128:129], v[144:145], s[90:91], v[24:25]
    v_pk_fma_f32 v[130:131], v[146:147], s[90:91], v[26:27]
    s_mov_b64 exec, -1
    v_max3_f32 v150, v120, v121, v122
    v_max3_f32 v152, v124, v125, v126
    v_max3_f32 v154, v128, v129, v130
    v_max_f32 v150, v150, v123
    v_max_f32 v152, v152, v127
    v_max_f32 v154, v154, v131
    v_permlane32_swap_b32 v148, v150
    s_nop 0
    v_permlane32_swap_b32 v152, v154
    v_max_f32 v148, v148, v150
    v_max_f32 v152, v152, v154
    s_nop 1
    v_permlane16_swap_b32 v148, v152
    v_max_f32 v148, v148, v152
    v_mov_b32 v152, v148
    s_nop 1
    v_permlane16_swap_b32 v148, v152
    v_mov_b32 v150, v148
    v_mov_b32 v154, v152
    s_nop 0
    v_permlane32_swap_b32 v148, v150
    v_permlane32_swap_b32 v152, v154
    v_pk_add_f32 v[116:117], v[116:117], v[148:149] op_sel:[0,0] op_sel_hi:[1,0] neg_lo:[0,1] neg_hi:[0,1]
    v_pk_add_f32 v[118:119], v[118:119], v[148:149] op_sel:[0,0] op_sel_hi:[1,0] neg_lo:[0,1] neg_hi:[0,1]
    v_pk_add_f32 v[120:121], v[120:121], v[150:151] op_sel:[0,0] op_sel_hi:[1,0] neg_lo:[0,1] neg_hi:[0,1]
    v_pk_add_f32 v[122:123], v[122:123], v[150:151] op_sel:[0,0] op_sel_hi:[1,0] neg_lo:[0,1] neg_hi:[0,1]
    v_pk_add_f32 v[124:125], v[124:125], v[152:153] op_sel:[0,0] op_sel_hi:[1,0] neg_lo:[0,1] neg_hi:[0,1]
    v_pk_add_f32 v[126:127], v[126:127], v[152:153] op_sel:[0,0] op_sel_hi:[1,0] neg_lo:[0,1] neg_hi:[0,1]
    v_pk_add_f32 v[128:129], v[128:129], v[154:155] op_sel:[0,0] op_sel_hi:[1,0] neg_lo:[0,1] neg_hi:[0,1]
    v_pk_add_f32 v[130:131], v[130:131], v[154:155] op_sel:[0,0] op_sel_hi:[1,0] neg_lo:[0,1] neg_hi:[0,1]
    s_waitcnt lgkmcnt(0)
    v_exp_f32 v116, v116
    v_exp_f32 v117, v117
    v_exp_f32 v118, v118
    v_exp_f32 v119, v119
    v_exp_f32 v120, v120
    v_exp_f32 v121, v121
    v_exp_f32 v122, v122
    v_exp_f32 v123, v123
    s_mov_b64 exec, s[72:73]
    v_cvt_pk_bf16_f32 v192, v116, v117
    v_cvt_pk_bf16_f32 v193, v118, v119
    v_cvt_pk_bf16_f32 v196, v120, v121
    v_cvt_pk_bf16_f32 v197, v122, v123
    s_mov_b64 exec, s[62:63]
    v_cvt_pk_bf16_f32 v194, v116, v117
    v_cvt_pk_bf16_f32 v195, v118, v119
    v_cvt_pk_bf16_f32 v198, v120, v121
    v_cvt_pk_bf16_f32 v199, v122, v123
    s_mov_b64 exec, -1
    v_exp_f32 v124, v124
    v_exp_f32 v125, v125
    v_exp_f32 v126, v126
    v_exp_f32 v127, v127
    v_mfma_f32_16x16x32_bf16 v[80:83], v[218:221], v[192:195], 0
    v_mfma_f32_16x16x32_bf16 v[64:67], v[208:211], v[192:195], 0
    v_exp_f32 v128, v128
    v_exp_f32 v129, v129
    v_exp_f32 v130, v130
    v_exp_f32 v131, v131
    v_mfma_f32_16x16x32_bf16 v[84:87], v[220:223], v[196:199], 0
    v_mfma_f32_16x16x32_bf16 v[68:71], v[210:213], v[196:199], 0
    s_mov_b64 exec, s[72:73]
    v_cvt_pk_bf16_f32 v200, v124, v125
    v_cvt_pk_bf16_f32 v201, v126, v127
    v_cvt_pk_bf16_f32 v204, v128, v129
    v_cvt_pk_bf16_f32 v205, v130, v131
    s_mov_b64 exec, s[62:63]
    v_cvt_pk_bf16_f32 v202, v124, v125
    v_cvt_pk_bf16_f32 v203, v126, v127
    v_cvt_pk_bf16_f32 v206, v128, v129
    v_cvt_pk_bf16_f32 v207, v130, v131
    s_mov_b64 exec, -1
    v_rcp_f32 v148, v82
    v_mfma_f32_16x16x32_bf16 v[88:91], v[222:225], v[200:203], 0
    v_mfma_f32_16x16x32_bf16 v[72:75], v[212:215], v[200:203], 0
    v_mfma_f32_16x16x32_bf16 v[92:95], v[224:227], v[204:207], 0
    v_mfma_f32_16x16x32_bf16 v[76:79], v[214:217], v[204:207], 0
    v_rcp_f32 v150, v86
    v_pk_mul_f32 v[64:65], v[64:65], v[148:149] op_sel:[0,0] op_sel_hi:[1,0]
    v_pk_mul_f32 v[66:67], v[66:67], v[148:149] op_sel:[0,0] op_sel_hi:[1,0]
    v_pk_mul_f32 v[80:81], v[80:81], v[148:149] op_sel:[0,0] op_sel_hi:[1,0]
    v_cvt_pk_bf16_f32 v116, v64, v65
    v_cvt_pk_bf16_f32 v117, v66, v67
    v_cvt_pk_bf16_f32 v124, v80, v81
    v_rcp_f32 v152, v90
    v_pk_mul_f32 v[68:69], v[68:69], v[150:151] op_sel:[0,0] op_sel_hi:[1,0]
    v_pk_mul_f32 v[70:71], v[70:71], v[150:151] op_sel:[0,0] op_sel_hi:[1,0]
    v_pk_mul_f32 v[84:85], v[84:85], v[150:151] op_sel:[0,0] op_sel_hi:[1,0]
    v_cvt_pk_bf16_f32 v118, v68, v69
    v_cvt_pk_bf16_f32 v119, v70, v71
    v_cvt_pk_bf16_f32 v125, v84, v85
    v_rcp_f32 v154, v94
    v_cndmask_b32 v124, v124, v125, s[16:17]
    v_permlane16_swap_b32 v116, v118
    v_permlane16_swap_b32 v117, v119
    buffer_store_dwordx4 v[116:119], v21, s[52:55], 0 offen sc1
    v_pk_mul_f32 v[72:73], v[72:73], v[152:153] op_sel:[0,0] op_sel_hi:[1,0]
    v_pk_mul_f32 v[74:75], v[74:75], v[152:153] op_sel:[0,0] op_sel_hi:[1,0]
    v_pk_mul_f32 v[88:89], v[88:89], v[152:153] op_sel:[0,0] op_sel_hi:[1,0]
    v_cvt_pk_bf16_f32 v120, v72, v73
    v_cvt_pk_bf16_f32 v121, v74, v75
    v_cvt_pk_bf16_f32 v126, v88, v89
    v_pk_mul_f32 v[76:77], v[76:77], v[154:155] op_sel:[0,0] op_sel_hi:[1,0]
    v_pk_mul_f32 v[78:79], v[78:79], v[154:155] op_sel:[0,0] op_sel_hi:[1,0]
    v_pk_mul_f32 v[92:93], v[92:93], v[154:155] op_sel:[0,0] op_sel_hi:[1,0]
    v_cvt_pk_bf16_f32 v122, v76, v77
    v_cvt_pk_bf16_f32 v123, v78, v79
    v_cvt_pk_bf16_f32 v127, v92, v93
    v_cndmask_b32 v124, v124, v126, s[18:19]
    v_cndmask_b32 v124, v124, v127, s[20:21]
    v_permlane16_swap_b32 v120, v122
    v_permlane16_swap_b32 v121, v123
    buffer_store_dwordx4 v[120:123], v22, s[52:55], 0 offen sc1
    buffer_store_dword v124, v23, s[52:55], 0 offen sc1
    v_lshrrev_b32 v58, 4, v1
    v_bfe_u32 v59, v1, 2, 2
    v_lshl_add_u32 v60, v58, 3, v59
    v_lshlrev_b32 v60, 7, v60
    v_and_b32 v61, 3, v1
    v_lshl_add_u32 v60, v61, 3, v60
    v_and_b32 v61, 1, v58
    v_lshlrev_b32 v61, 1, v61
    v_lshrrev_b32 v59, 1, v59
    v_or_b32 v61, v61, v59
    v_lshl_add_u32 v60, v61, 5, v60
    v_add_u32 v42, 0, v60
    s_and_b32 s9, s3, 3
    s_lshl_b32 s10, s9, 5
    v_xor_b32 v42, s10, v42
    s_lshr_b32 s10, s3, 2
    s_mul_i32 s10, s10, 36864
    v_add_u32 v42, s10, v42
    s_lshl_b32 s9, s9, 10
    s_add_u32 s10, s10, s9
    v_lshlrev_b32 v44, 4, v1
    v_add_u32 v44, 0, v44
    v_add_u32 v43, s10, v44
    v_add_u32 v45, 49152, v44
    v_lshlrev_b32 v46, 4, v1
    s_lshl_b32 s9, s66, 3
    s_add_u32 s9, s9, s3
    s_mul_i32 s64, s9, 18432
    s_mov_b32 s10, 0
    s_add_u32 s10, s10, 0
    s_and_b32 s10, s10, 7
    s_lshl_b32 s10, s10, 11
    s_add_u32 s74, s10, s64
    s_mov_b32 s10, 0
    s_add_u32 s10, s10, 1
    s_and_b32 s10, s10, 7
    s_lshl_b32 s10, s10, 11
    s_add_u32 s75, s10, s64
    s_mov_b32 s10, 0
    s_add_u32 s10, s10, 2
    s_and_b32 s10, s10, 7
    s_lshl_b32 s10, s10, 11
    s_add_u32 s76, s10, s64
    s_mov_b32 s10, 0
    s_add_u32 s10, s10, 3
    s_and_b32 s10, s10, 7
    s_lshl_b32 s10, s10, 11
    s_add_u32 s77, s10, s64
    s_mov_b32 s10, 0
    s_add_u32 s10, s10, 4
    s_and_b32 s10, s10, 7
    s_lshl_b32 s10, s10, 11
    s_add_u32 s78, s10, s64
    s_mov_b32 s10, 0
    s_add_u32 s10, s10, 5
    s_and_b32 s10, s10, 7
    s_lshl_b32 s10, s10, 11
    s_add_u32 s79, s10, s64
    s_mov_b32 s10, 0
    s_add_u32 s10, s10, 6
    s_and_b32 s10, s10, 7
    s_lshl_b32 s10, s10, 11
    s_add_u32 s80, s10, s64
    s_mov_b32 s10, 0
    s_add_u32 s10, s10, 7
    s_and_b32 s10, s10, 7
    s_lshl_b32 s10, s10, 11
    s_add_u32 s81, s10, s64
    s_add_u32 s82, s64, 16384
    s_lshr_b32 s10, s9, 1
    s_lshl_b32 s69, s10, 5
    s_add_u32 s10, s69, s14
    v_and_b32 v59, 15, v1
    v_lshl_add_u32 v59, v59, 1, s10
    v_mul_u32_u24 v59, 2304, v59
    v_and_b32 v60, 1, v58
    v_lshl_add_u32 v59, v60, 5, v59
    v_lshrrev_b32 v60, 1, v58
    v_lshl_add_u32 v59, v60, 4, v59
    s_lshl_b32 s9, s67, 7
    s_add_u32 s9, s9, 1152
    v_add_u32 v49, s9, v59
    s_add_u32 s10, s69, 17
    s_mul_i32 s10, s10, 575
    s_lshr_b32 s10, s10, 16
    s_max_u32 s9, s69, 14
    s_sub_u32 s9, s9, 14
    s_mul_i32 s9, s9, 575
    s_lshr_b32 s9, s9, 16
    v_cmp_gt_u32 vcc, 8, v1
    v_mov_b32 v47, s10
    v_mov_b32 v48, s9
    v_cndmask_b32 v47, v47, v48, vcc
    v_and_b32 v48, 7, v1
    v_lshl_add_u32 v47, v47, 3, v48
    v_mul_u32_u24 v47, 128, v47
    ds_read_b64_tr_b16 v[64:65], v42 offset:0
    ds_read_b64_tr_b16 v[66:67], v42 offset:512
    ds_read_b64_tr_b16 v[68:69], v42 offset:4096
    ds_read_b64_tr_b16 v[70:71], v42 offset:4608
    ds_read_b64_tr_b16 v[72:73], v42 offset:8192
    ds_read_b64_tr_b16 v[74:75], v42 offset:8704
    ds_read_b64_tr_b16 v[76:77], v42 offset:12288
    ds_read_b64_tr_b16 v[78:79], v42 offset:12800
    ds_read_b64_tr_b16 v[80:81], v42 offset:16384
    ds_read_b64_tr_b16 v[82:83], v42 offset:16896
    ds_read_b64_tr_b16 v[84:85], v42 offset:20480
    ds_read_b64_tr_b16 v[86:87], v42 offset:20992
    ds_read_b64_tr_b16 v[88:89], v42 offset:24576
    ds_read_b64_tr_b16 v[90:91], v42 offset:25088
    ds_read_b64_tr_b16 v[92:93], v42 offset:28672
    ds_read_b64_tr_b16 v[94:95], v42 offset:29184
    ds_read_b64_tr_b16 v[96:97], v42 offset:32768
    ds_read_b64_tr_b16 v[98:99], v42 offset:33280
    s_waitcnt lgkmcnt(0)
    s_mov_b32 s11, 0
L_tb_m:
    v_cmp_eq_u32 vcc, 0, v242
    s_cbranch_vccz L_ub_m
    s_mov_b32 s48, s36
    s_and_b32 s49, s37, 0xffff
    s_mov_b32 s50, 256
    s_mov_b32 s51, 0x20000
    v_mov_b32 v241, 0
    buffer_load_dwordx2 v[242:243], v241, s[48:51], 0 offen sc1
    s_waitcnt vmcnt(0)
    s_add_u32 s11, s11, 1
    s_cmp_lt_u32 s11, 65536
    s_cbranch_scc1 L_tb_m
L_ub_m:
    s_add_u32 s48, s38, 4718592
    s_addc_u32 s49, s39, 0
    s_and_b32 s49, s49, 0xffff
    s_mov_b32 s50, 27648
    s_mov_b32 s51, 0x20000
    v_mov_b32 v241, s22
    s_cmp_lg_u32 s3, 0
    s_waitcnt vmcnt(0)
    s_barrier
    s_cbranch_scc1 L_sb_m
    s_mov_b64 exec, 1
    buffer_store_dwordx2 v[242:243], v241, s[48:51], 0 offen sc1
    s_mov_b64 exec, -1
L_sb_m:
    ds_write_b128 v43, v[64:67] offset:0
    ds_write_b128 v43, v[68:71] offset:4096
    ds_write_b128 v43, v[72:75] offset:8192
    ds_write_b128 v43, v[76:79] offset:12288
    ds_write_b128 v43, v[80:83] offset:16384
    ds_write_b128 v43, v[84:87] offset:20480
    ds_write_b128 v43, v[88:91] offset:24576
    ds_write_b128 v43, v[92:95] offset:28672
    ds_write_b128 v43, v[96:99] offset:32768
    s_waitcnt lgkmcnt(0)
    s_barrier
    ds_read_b128 v[136:139], v44 offset:0
    ds_read_b128 v[140:143], v44 offset:1024
    ds_read_b128 v[144:147], v44 offset:2048
    ds_read_b128 v[148:151], v44 offset:3072
    ds_read_b128 v[152:155], v44 offset:4096
    ds_read_b128 v[156:159], v44 offset:5120
    ds_read_b128 v[160:163], v44 offset:6144
    ds_read_b128 v[164:167], v44 offset:7168
    ds_read_b128 v[168:171], v44 offset:8192
    ds_read_b128 v[172:175], v44 offset:9216
    ds_read_b128 v[176:179], v44 offset:10240
    ds_read_b128 v[180:183], v44 offset:11264
    ds_read_b128 v[184:187], v44 offset:12288
    ds_read_b128 v[188:191], v44 offset:13312
    ds_read_b128 v[192:195], v44 offset:14336
    ds_read_b128 v[196:199], v44 offset:15360
    ds_read_b128 v[200:203], v44 offset:16384
    ds_read_b128 v[204:207], v44 offset:17408
    ds_read_b128 v[208:211], v44 offset:18432
    ds_read_b128 v[212:215], v44 offset:19456
    s_mov_b64 exec, 65535
L_pb_m:
    buffer_load_dwordx2 v[244:245], v47, s[48:51], 0 offen sc1
    s_waitcnt vmcnt(0)
    v_cmp_ne_u64 vcc, v[244:245], v[242:243]
    s_cbranch_vccz L_db_m
    s_sleep 1
    s_add_u32 s11, s11, 1
    s_cmp_lt_u32 s11, 65536
    s_cbranch_scc1 L_pb_m
L_db_m:
    s_mov_b64 exec, -1
    s_mov_b32 s56, s34
    s_and_b32 s57, s35, 0xffff
    s_mov_b32 s58, 4718592
    s_mov_b32 s59, 0x20000
L_go_m:
    buffer_load_dwordx4 v[64:67], v46, s[52:55], s74 offen offset:0 sc1
    buffer_load_dwordx4 v[68:71], v46, s[52:55], s74 offen offset:1024 sc1
    buffer_load_dwordx4 v[72:75], v46, s[52:55], s75 offen offset:0 sc1
    buffer_load_dwordx4 v[76:79], v46, s[52:55], s75 offen offset:1024 sc1
    buffer_load_dwordx4 v[80:83], v46, s[52:55], s76 offen offset:0 sc1
    buffer_load_dwordx4 v[84:87], v46, s[52:55], s76 offen offset:1024 sc1
    buffer_load_dwordx4 v[88:91], v46, s[52:55], s77 offen offset:0 sc1
    buffer_load_dwordx4 v[92:95], v46, s[52:55], s77 offen offset:1024 sc1
    s_waitcnt vmcnt(7) lgkmcnt(15)
    v_mfma_f32_16x16x32_bf16 v[232:235], v[136:139], v[64:67], 0
    buffer_load_dwordx4 v[96:99], v46, s[52:55], s78 offen offset:0 sc1
    v_mfma_f32_16x16x32_bf16 v[236:239], v[140:143], v[64:67], 0
    ds_read_b128 v[216:219], v44 offset:20480
    v_mfma_f32_16x16x32_bf16 v[240:243], v[144:147], v[64:67], 0
    ds_read_b128 v[220:223], v44 offset:21504
    ds_read_b128 v[224:227], v44 offset:22528
    v_mfma_f32_16x16x32_bf16 v[244:247], v[148:151], v[64:67], 0
    ds_read_b128 v[228:231], v44 offset:23552
    s_waitcnt vmcnt(7) lgkmcnt(15)
    v_mfma_f32_16x16x32_bf16 v[232:235], v[152:155], v[68:71], v[232:235]
    buffer_load_dwordx4 v[100:103], v46, s[52:55], s78 offen offset:1024 sc1
    v_mfma_f32_16x16x32_bf16 v[236:239], v[156:159], v[68:71], v[236:239]
    ds_read_b128 v[136:139], v44 offset:24576
    v_mfma_f32_16x16x32_bf16 v[240:243], v[160:163], v[68:71], v[240:243]
    ds_read_b128 v[140:143], v44 offset:25600
    ds_read_b128 v[144:147], v44 offset:26624
    v_mfma_f32_16x16x32_bf16 v[244:247], v[164:167], v[68:71], v[244:247]
    ds_read_b128 v[148:151], v44 offset:27648
    s_waitcnt vmcnt(7) lgkmcnt(15)
    v_mfma_f32_16x16x32_bf16 v[232:235], v[168:171], v[72:75], v[232:235]
    buffer_load_dwordx4 v[104:107], v46, s[52:55], s79 offen offset:0 sc1
    v_mfma_f32_16x16x32_bf16 v[236:239], v[172:175], v[72:75], v[236:239]
    ds_read_b128 v[152:155], v44 offset:28672
    v_mfma_f32_16x16x32_bf16 v[240:243], v[176:179], v[72:75], v[240:243]
    ds_read_b128 v[156:159], v44 offset:29696
    ds_read_b128 v[160:163], v44 offset:30720
    v_mfma_f32_16x16x32_bf16 v[244:247], v[180:183], v[72:75], v[244:247]
    ds_read_b128 v[164:167], v44 offset:31744
    s_waitcnt vmcnt(7) lgkmcnt(15)
    v_mfma_f32_16x16x32_bf16 v[232:235], v[184:187], v[76:79], v[232:235]
    buffer_load_dwordx4 v[108:111], v46, s[52:55], s79 offen offset:1024 sc1
    v_mfma_f32_16x16x32_bf16 v[236:239], v[188:191], v[76:79], v[236:239]
    ds_read_b128 v[168:171], v44 offset:32768
    v_mfma_f32_16x16x32_bf16 v[240:243], v[192:195], v[76:79], v[240:243]
    ds_read_b128 v[172:175], v44 offset:33792
    ds_read_b128 v[176:179], v44 offset:34816
    v_mfma_f32_16x16x32_bf16 v[244:247], v[196:199], v[76:79], v[244:247]
    ds_read_b128 v[180:183], v44 offset:35840
    s_waitcnt vmcnt(7) lgkmcnt(15)
    v_mfma_f32_16x16x32_bf16 v[232:235], v[200:203], v[80:83], v[232:235]
    buffer_load_dwordx4 v[112:115], v46, s[52:55], s80 offen offset:0 sc1
    v_mfma_f32_16x16x32_bf16 v[236:239], v[204:207], v[80:83], v[236:239]
    ds_read_b128 v[184:187], v44 offset:36864
    v_mfma_f32_16x16x32_bf16 v[240:243], v[208:211], v[80:83], v[240:243]
    ds_read_b128 v[188:191], v44 offset:37888
    ds_read_b128 v[192:195], v44 offset:38912
    v_mfma_f32_16x16x32_bf16 v[244:247], v[212:215], v[80:83], v[244:247]
    ds_read_b128 v[196:199], v44 offset:39936
    s_waitcnt vmcnt(7) lgkmcnt(15)
    v_mfma_f32_16x16x32_bf16 v[232:235], v[216:219], v[84:87], v[232:235]
    buffer_load_dwordx4 v[116:119], v46, s[52:55], s80 offen offset:1024 sc1
    v_mfma_f32_16x16x32_bf16 v[236:239], v[220:223], v[84:87], v[236:239]
    ds_read_b128 v[200:203], v44 offset:40960
    v_mfma_f32_16x16x32_bf16 v[240:243], v[224:227], v[84:87], v[240:243]
    ds_read_b128 v[204:207], v44 offset:41984
    ds_read_b128 v[208:211], v44 offset:43008
    v_mfma_f32_16x16x32_bf16 v[244:247], v[228:231], v[84:87], v[244:247]
    ds_read_b128 v[212:215], v44 offset:44032
    s_waitcnt vmcnt(7) lgkmcnt(15)
    v_mfma_f32_16x16x32_bf16 v[232:235], v[136:139], v[88:91], v[232:235]
    buffer_load_dwordx4 v[120:123], v46, s[52:55], s81 offen offset:0 sc1
    v_mfma_f32_16x16x32_bf16 v[236:239], v[140:143], v[88:91], v[236:239]
    ds_read_b128 v[216:219], v44 offset:45056
    v_mfma_f32_16x16x32_bf16 v[240:243], v[144:147], v[88:91], v[240:243]
    ds_read_b128 v[220:223], v44 offset:46080
    ds_read_b128 v[224:227], v44 offset:47104
    v_mfma_f32_16x16x32_bf16 v[244:247], v[148:151], v[88:91], v[244:247]
    ds_read_b128 v[228:231], v44 offset:48128
    s_waitcnt vmcnt(7) lgkmcnt(15)
    v_mfma_f32_16x16x32_bf16 v[232:235], v[152:155], v[92:95], v[232:235]
    buffer_load_dwordx4 v[124:127], v46, s[52:55], s81 offen offset:1024 sc1
    v_mfma_f32_16x16x32_bf16 v[236:239], v[156:159], v[92:95], v[236:239]
    ds_read_b128 v[136:139], v45 offset:0
    v_mfma_f32_16x16x32_bf16 v[240:243], v[160:163], v[92:95], v[240:243]
    ds_read_b128 v[140:143], v45 offset:1024
    ds_read_b128 v[144:147], v45 offset:2048
    v_mfma_f32_16x16x32_bf16 v[244:247], v[164:167], v[92:95], v[244:247]
    ds_read_b128 v[148:151], v45 offset:3072
    s_waitcnt vmcnt(7) lgkmcnt(15)
    v_mfma_f32_16x16x32_bf16 v[232:235], v[168:171], v[96:99], v[232:235]
    buffer_load_dwordx4 v[128:131], v46, s[52:55], s82 offen offset:0 sc1
    v_mfma_f32_16x16x32_bf16 v[236:239], v[172:175], v[96:99], v[236:239]
    ds_read_b128 v[152:155], v45 offset:4096
    v_mfma_f32_16x16x32_bf16 v[240:243], v[176:179], v[96:99], v[240:243]
    ds_read_b128 v[156:159], v45 offset:5120
    ds_read_b128 v[160:163], v45 offset:6144
    v_mfma_f32_16x16x32_bf16 v[244:247], v[180:183], v[96:99], v[244:247]
    ds_read_b128 v[164:167], v45 offset:7168
    s_waitcnt vmcnt(7) lgkmcnt(15)
    v_mfma_f32_16x16x32_bf16 v[232:235], v[184:187], v[100:103], v[232:235]
    buffer_load_dwordx4 v[132:135], v46, s[52:55], s82 offen offset:1024 sc1
    v_mfma_f32_16x16x32_bf16 v[236:239], v[188:191], v[100:103], v[236:239]
    ds_read_b128 v[168:171], v45 offset:8192
    v_mfma_f32_16x16x32_bf16 v[240:243], v[192:195], v[100:103], v[240:243]
    ds_read_b128 v[172:175], v45 offset:9216
    ds_read_b128 v[176:179], v45 offset:10240
    v_mfma_f32_16x16x32_bf16 v[244:247], v[196:199], v[100:103], v[244:247]
    ds_read_b128 v[180:183], v45 offset:11264
    s_waitcnt vmcnt(7) lgkmcnt(15)
    v_mfma_f32_16x16x32_bf16 v[232:235], v[200:203], v[104:107], v[232:235]
    ds_read_b128 v[184:187], v45 offset:12288
    v_mfma_f32_16x16x32_bf16 v[236:239], v[204:207], v[104:107], v[236:239]
    ds_read_b128 v[188:191], v45 offset:13312
    v_mfma_f32_16x16x32_bf16 v[240:243], v[208:211], v[104:107], v[240:243]
    ds_read_b128 v[192:195], v45 offset:14336
    v_mfma_f32_16x16x32_bf16 v[244:247], v[212:215], v[104:107], v[244:247]
    ds_read_b128 v[196:199], v45 offset:15360
    s_waitcnt vmcnt(6) lgkmcnt(15)
    v_mfma_f32_16x16x32_bf16 v[232:235], v[216:219], v[108:111], v[232:235]
    ds_read_b128 v[200:203], v45 offset:16384
    v_mfma_f32_16x16x32_bf16 v[236:239], v[220:223], v[108:111], v[236:239]
    ds_read_b128 v[204:207], v45 offset:17408
    v_mfma_f32_16x16x32_bf16 v[240:243], v[224:227], v[108:111], v[240:243]
    ds_read_b128 v[208:211], v45 offset:18432
    v_mfma_f32_16x16x32_bf16 v[244:247], v[228:231], v[108:111], v[244:247]
    ds_read_b128 v[212:215], v45 offset:19456
    s_waitcnt vmcnt(5) lgkmcnt(15)
    v_mfma_f32_16x16x32_bf16 v[232:235], v[136:139], v[112:115], v[232:235]
    ds_read_b128 v[216:219], v45 offset:20480
    v_mfma_f32_16x16x32_bf16 v[236:239], v[140:143], v[112:115], v[236:239]
    ds_read_b128 v[220:223], v45 offset:21504
    v_mfma_f32_16x16x32_bf16 v[240:243], v[144:147], v[112:115], v[240:243]
    ds_read_b128 v[224:227], v45 offset:22528
    v_mfma_f32_16x16x32_bf16 v[244:247], v[148:151], v[112:115], v[244:247]
    ds_read_b128 v[228:231], v45 offset:23552
    s_waitcnt vmcnt(4) lgkmcnt(15)
    v_mfma_f32_16x16x32_bf16 v[232:235], v[152:155], v[116:119], v[232:235]
    v_mfma_f32_16x16x32_bf16 v[236:239], v[156:159], v[116:119], v[236:239]
    v_mfma_f32_16x16x32_bf16 v[240:243], v[160:163], v[116:119], v[240:243]
    v_mfma_f32_16x16x32_bf16 v[244:247], v[164:167], v[116:119], v[244:247]
    s_waitcnt vmcnt(3) lgkmcnt(12)
    v_mfma_f32_16x16x32_bf16 v[232:235], v[168:171], v[120:123], v[232:235]
    v_mfma_f32_16x16x32_bf16 v[236:239], v[172:175], v[120:123], v[236:239]
    v_mfma_f32_16x16x32_bf16 v[240:243], v[176:179], v[120:123], v[240:243]
    v_mfma_f32_16x16x32_bf16 v[244:247], v[180:183], v[120:123], v[244:247]
    s_waitcnt vmcnt(2) lgkmcnt(8)
    v_mfma_f32_16x16x32_bf16 v[232:235], v[184:187], v[124:127], v[232:235]
    v_mfma_f32_16x16x32_bf16 v[236:239], v[188:191], v[124:127], v[236:239]
    v_mfma_f32_16x16x32_bf16 v[240:243], v[192:195], v[124:127], v[240:243]
    v_mfma_f32_16x16x32_bf16 v[244:247], v[196:199], v[124:127], v[244:247]
    s_waitcnt vmcnt(1) lgkmcnt(4)
    v_mfma_f32_16x16x32_bf16 v[232:235], v[200:203], v[128:131], v[232:235]
    v_mfma_f32_16x16x32_bf16 v[236:239], v[204:207], v[128:131], v[236:239]
    v_mfma_f32_16x16x32_bf16 v[240:243], v[208:211], v[128:131], v[240:243]
    v_mfma_f32_16x16x32_bf16 v[244:247], v[212:215], v[128:131], v[244:247]
    s_waitcnt vmcnt(0) lgkmcnt(0)
    v_mfma_f32_16x16x32_bf16 v[232:235], v[216:219], v[132:135], v[232:235]
    v_mfma_f32_16x16x32_bf16 v[236:239], v[220:223], v[132:135], v[236:239]
    v_mfma_f32_16x16x32_bf16 v[240:243], v[224:227], v[132:135], v[240:243]
    v_mfma_f32_16x16x32_bf16 v[244:247], v[228:231], v[132:135], v[244:247]
    s_nop 4
    v_cvt_pk_bf16_f32 v64, v232, v233
    v_cvt_pk_bf16_f32 v65, v234, v235
    v_cvt_pk_bf16_f32 v66, v236, v237
    v_cvt_pk_bf16_f32 v67, v238, v239
    v_cvt_pk_bf16_f32 v68, v240, v241
    v_cvt_pk_bf16_f32 v69, v242, v243
    v_cvt_pk_bf16_f32 v70, v244, v245
    v_cvt_pk_bf16_f32 v71, v246, v247
    v_permlane16_swap_b32 v64, v66
    v_permlane16_swap_b32 v65, v67
    v_permlane16_swap_b32 v68, v70
    v_permlane16_swap_b32 v69, v71
    buffer_store_dwordx4 v[64:67], v49, s[56:59], 0 offen offset:0
    buffer_store_dwordx4 v[68:71], v49, s[56:59], 0 offen offset:64
    s_endpgm
    .p2align 10
L_roleA_m:
    s_lshl_b32 s6, s4, 3
    s_add_u32 s6, s6, s5
    s_sub_u32 s6, s6, 18
    s_add_u32 s7, s4, 64
    s_cmp_eq_u32 s5, 26
    s_cselect_b32 s6, s7, s6
    s_lshr_b32 s7, s6, 3
    s_and_b32 s8, s6, 7
    v_and_b32 v7, 7, v1
    v_lshrrev_b32 v8, 3, v1
    v_mul_u32_u24 v2, 1152, v8
    v_lshl_add_u32 v2, v7, 4, v2
    s_lshl_b32 s9, s7, 7
    v_add_u32 v2, s9, v2
    s_mul_i32 s10, s8, 294912
    s_mul_i32 s11, s3, 9216
    s_add_u32 s11, s11, s10
    s_mul_i32 s12, s3, 1088
    s_add_u32 s12, s12, 68160
    s_sub_u32 s13, s10, 9216
    s_cmp_eq_u32 s8, 0
    s_cselect_b32 s13, 2147483648, s13
    s_sub_u32 s9, s5, 18
    s_mul_i32 s14, s3, 9
    s_add_u32 s9, s9, s14
    s_mul_i32 s9, s9, 64
    s_add_u32 s9, s9, 1200
    v_cmp_gt_u32 vcc, 64, v1
    v_add_u32 v10, s9, v1
    v_mov_b32 v11, 15616
    v_cndmask_b32 v10, v11, v10, vcc
    v_mul_u32_u24 v13, 10382, v10
    v_lshrrev_b32 v13, 24, v13
    v_mul_u32_u24 v14, 1616, v13
    v_sub_u32 v14, v10, v14
    v_cmp_gt_u32 vcc, 1040, v14
    v_mul_u32_u24 v11, 1152, v14
    v_lshl_add_u32 v11, v13, 7, v11
    v_subrev_u32 v14, 1040, v14
    v_and_b32 v14, 0x3ff, v14
    v_mul_u32_u24 v15, 7282, v14
    v_lshrrev_b32 v15, 16, v15
    v_mul_u32_u24 v16, 9, v15
    v_sub_u32 v14, v14, v16
    v_lshl_add_u32 v15, v13, 6, v15
    v_mul_u32_u24 v15, 3456, v15
    v_mul_u32_u24 v16, 171, v14
    v_lshrrev_b32 v16, 9, v16
    v_mul_u32_u24 v16, 768, v16
    v_lshl_add_u32 v16, v14, 7, v16
    v_add_u32 v12, v15, v16
    v_mov_b32 v13, 2147483648
    v_cndmask_b32 v11, v13, v11, vcc
    v_cndmask_b32 v12, v12, v13, vcc
    s_lshr_b32 s77, s4, 1
    s_mul_i32 s77, s77, 288
    s_and_b32 s77, s77, 0xffffff80
    s_and_b32 s76, s4, 1
    s_mul_i32 s76, s76, 1181952
    s_waitcnt lgkmcnt(0)
    s_mov_b32 s40, s28
    s_and_b32 s41, s29, 0xffff
    s_mov_b32 s42, 2359296
    s_mov_b32 s43, 0x20000
    s_mov_b32 s44, s30
    s_and_b32 s45, s31, 0xffff
    s_mov_b32 s46, 1990656
    s_mov_b32 s47, 0x20000
    buffer_load_dword v250, v11, s[40:43], s76 offen
    buffer_load_dword v251, v12, s[44:47], s77 offen
    s_mov_b32 s56, s24
    s_and_b32 s57, s25, 0xffff
    s_mov_b32 s58, 2359296
    s_mov_b32 s59, 0x20000
    s_lshl_b32 s15, s6, 3
    s_add_u32 s15, s15, s3
    s_lshl_b32 s60, s15, 12
    v_lshlrev_b32 v223, 4, v1
    v_add_u32 v224, s60, v223
    s_lshr_b32 s61, s15, 1
    s_lshl_b32 s61, s61, 2
    s_load_dword s62, s[26:27], s61
    s_mul_i32 s63, s3, 8384
    s_mul_i32 s67, s3, 4576
    s_add_u32 s67, s67, 67072
    v_add_u32 v222, s63, v223
    v_add_u32 v226, s67, v223
    v_lshlrev_b32 v227, 3, v1
    v_add_u32 v225, s67, v227
    v_add_u32 v227, s63, v227
    v_and_b32 v228, 15, v1
    v_lshrrev_b32 v229, 4, v1
    v_and_b32 v230, 1, v1
    v_cmp_eq_u32 vcc, 1, v230
    v_mov_b32 v231, 4164
    v_lshlrev_b32 v230, 5, v228
    v_cndmask_b32 v231, v231, 2, vcc
    v_lshl_add_u32 v231, v228, 1, v231
    v_lshl_add_u32 v231, v229, 4, v231
    v_add_u32 v212, s63, v231
    v_add_u32 v213, 1024, v212
    v_add_u32 v214, 2048, v212
    v_add_u32 v215, 3072, v212
    v_sub_u32 v231, 480, v230
    v_lshl_add_u32 v231, v229, 4, v231
    v_add_u32 v216, s67, v231
    v_lshl_add_u32 v231, v229, 3, v230
    v_add_u32 v218, s63, v231
    v_lshl_add_u32 v232, v229, 3, v228
    v_sub_u32 v217, 15, v232
    v_bfe_u32 v231, v1, 2, 2
    v_mul_u32_u24 v231, 8384, v231
    v_lshl_add_u32 v231, v229, 5, v231
    v_and_b32 v232, 3, v1
    v_lshl_add_u32 v231, v232, 3, v231
    s_add_u32 s66, s3, s6
    s_and_b32 s66, s66, 7
    s_lshl_b32 s64, s66, 8
    v_add_u32 v219, s64, v231
    s_lshl_b32 s64, s66, 7
    s_add_u32 s64, s64, 1024
    v_add_u32 v231, s64, v1
    s_lshl_b32 s65, s6, 4
    v_mul_u32_u24 v220, 1152, v231
    v_add_u32 v220, s65, v220
    v_mul_u32_u24 v221, 2304, v231
    v_add_u32 v221, s65, v221
    s_add_u32 s68, s6, 144
    s_and_b32 s9, s68, 0xf8
    s_mul_i32 s68, s68, 128
    s_mul_i32 s9, s9, 128
    v_mul_u32_u24 v233, 128, v1
    v_add_u32 v233, s9, v233
    v_mov_b32 v228, 0
    v_mov_b32 v229, 0
    s_mov_b32 s40, s18
    s_and_b32 s41, s19, 0xffff
    s_mov_b32 s42, 2359296
    s_mov_b32 s43, 0x20000
    s_mov_b32 s44, s20
    s_and_b32 s45, s21, 0xffff
    s_mov_b32 s46, 2359296
    s_mov_b32 s47, 0x20000
    s_add_u32 m0, s12, 0
    s_add_u32 s14, s11, 0
    buffer_load_dwordx4 v2, s[40:43], s14 offen nt lds
    s_add_u32 m0, s12, 34816
    s_nop 0
    buffer_load_dwordx4 v2, s[44:47], s14 offen nt lds
    s_add_u32 m0, s12, 8704
    s_add_u32 s14, s11, 73728
    buffer_load_dwordx4 v2, s[40:43], s14 offen nt lds
    s_add_u32 m0, s12, 43520
    s_nop 0
    buffer_load_dwordx4 v2, s[44:47], s14 offen nt lds
    s_add_u32 m0, s12, 17408
    s_add_u32 s14, s11, 147456
    buffer_load_dwordx4 v2, s[40:43], s14 offen nt lds
    s_add_u32 m0, s12, 52224
    s_nop 0
    buffer_load_dwordx4 v2, s[44:47], s14 offen nt lds
    s_add_u32 m0, s12, 26112
    s_add_u32 s14, s11, 221184
    buffer_load_dwordx4 v2, s[40:43], s14 offen nt lds
    s_add_u32 m0, s12, 60928
    s_nop 0
    buffer_load_dwordx4 v2, s[44:47], s14 offen nt lds
    s_cmp_lg_u32 s3, 7
    s_cbranch_scc1 L_nohalo_m
    s_mov_b32 m0, 67072
    s_nop 0
    buffer_load_dwordx4 v2, s[40:43], s13 offen lds
L_nohalo_m:
    s_lshl_b32 s8, s8, 8
    s_lshr_b32 s9, s3, 1
    s_mul_i32 s10, s9, 8704
    s_lshl_b32 s9, s9, 6
    s_add_u32 s8, s8, s9
    s_lshl_b32 s7, s7, 6
    s_and_b32 s9, s3, 1
    s_lshl_b32 s11, s9, 6
    s_add_u32 s10, s10, s11
    s_add_u32 s10, s10, 67072
    s_lshl_b32 s9, s9, 5
    s_add_u32 s7, s7, s9
    v_mul_u32_u24 v3, 1088, v8
    v_lshl_add_u32 v3, v7, 3, v3
    v_add_u32 v3, s10, v3
    v_lshlrev_b32 v9, 3, v8
    v_add_u32 v9, s8, v9
    v_lshlrev_b32 v7, 2, v7
    v_add_u32 v7, s7, v7
    v_lshlrev_b32 v5, 3, v7
    s_mov_b32 s48, s22
    s_and_b32 s49, s23, 0xffff
    s_mov_b32 s50, 4608
    s_mov_b32 s51, 0x20000
    buffer_load_dwordx4 v[48:51], v5, s[48:51], 0 offen
    buffer_load_dwordx4 v[52:55], v5, s[48:51], 0 offen offset:16
    v_lshlrev_b32 v6, 12, v7
    v_sub_u32 v8, 2040, v9
    v_lshl_add_u32 v6, v8, 1, v6
    s_mov_b32 s52, s38
    s_and_b32 s53, s39, 0xffff
    s_mov_b32 s54, 2359296
    s_mov_b32 s55, 0x20000
    s_mov_b32 s10, 0x05040100
    s_mov_b32 s11, 0x07060302
    s_movk_i32 s12, 0x1000
    s_movk_i32 s13, 0x2000
    s_movk_i32 s14, 0x3000
    s_waitcnt vmcnt(0)
    s_barrier
    ds_read_b64 v[10:11], v3 offset:640
    ds_read_b64 v[12:13], v3 offset:768
    ds_read_b64 v[14:15], v3 offset:896
    ds_read_b64 v[16:17], v3 offset:1088
    ds_read_b64 v[18:19], v3 offset:1216
    ds_read_b64 v[20:21], v3 offset:1344
    ds_read_b64 v[22:23], v3 offset:1472
    ds_read_b64 v[24:25], v3 offset:1600
    ds_read_b64 v[26:27], v3 offset:1728
    ds_read_b64 v[28:29], v3 offset:1856
    ds_read_b64 v[30:31], v3 offset:1984
    ds_read_b64 v[32:33], v3 offset:35904
    ds_read_b64 v[34:35], v3 offset:36032
    ds_read_b64 v[36:37], v3 offset:36160
    ds_read_b64 v[38:39], v3 offset:36288
    s_mov_b64 exec, 15
    ds_write_b64 v227, v[228:229] offset:0
    ds_write_b64 v227, v[228:229] offset:4160
    s_mov_b64 exec, -1
    s_add_u32 m0, s63, 32
    s_add_u32 s61, s60, 0
    buffer_load_dwordx4 v223, s[56:59], s61 offen offset:0 nt lds
    buffer_load_dwordx4 v223, s[56:59], s61 offen offset:1024 nt lds
    buffer_load_dwordx4 v223, s[56:59], s61 offen offset:2048 nt lds
    buffer_load_dwordx4 v223, s[56:59], s61 offen offset:3072 nt lds
    s_mov_b32 s48, s36
    s_and_b32 s49, s37, 0xffff
    s_mov_b32 s50, 256
    s_mov_b32 s51, 0x20000
    v_mov_b32 v241, 0
    buffer_load_dwordx2 v[242:243], v241, s[48:51], 0 offen sc1
    s_waitcnt lgkmcnt(13)
    v_perm_b32 v56, v10, v12, s10
    v_perm_b32 v66, v10, v12, s11
    v_perm_b32 v76, v11, v13, s10
    v_perm_b32 v86, v11, v13, s11
    v_perm_b32 v57, v12, v14, s10
    v_perm_b32 v67, v12, v14, s11
    v_perm_b32 v77, v13, v15, s10
    v_perm_b32 v87, v13, v15, s11
    v_perm_b32 v58, v14, v16, s10
    v_perm_b32 v68, v14, v16, s11
    v_perm_b32 v78, v15, v17, s10
    v_perm_b32 v88, v15, v17, s11
    s_waitcnt lgkmcnt(10)
    v_perm_b32 v59, v16, v18, s10
    v_perm_b32 v69, v16, v18, s11
    v_perm_b32 v79, v17, v19, s10
    v_perm_b32 v89, v17, v19, s11
    v_perm_b32 v60, v18, v20, s10
    v_perm_b32 v70, v18, v20, s11
    v_perm_b32 v80, v19, v21, s10
    v_perm_b32 v90, v19, v21, s11
    v_perm_b32 v61, v20, v22, s10
    v_perm_b32 v71, v20, v22, s11
    v_perm_b32 v81, v21, v23, s10
    v_perm_b32 v91, v21, v23, s11
    s_waitcnt lgkmcnt(6)
    v_perm_b32 v62, v22, v24, s10
    v_perm_b32 v72, v22, v24, s11
    v_perm_b32 v82, v23, v25, s10
    v_perm_b32 v92, v23, v25, s11
    v_perm_b32 v63, v24, v26, s10
    v_perm_b32 v73, v24, v26, s11
    v_perm_b32 v83, v25, v27, s10
    v_perm_b32 v93, v25, v27, s11
    v_perm_b32 v64, v26, v28, s10
    v_perm_b32 v74, v26, v28, s11
    v_perm_b32 v84, v27, v29, s10
    v_perm_b32 v94, v27, v29, s11
    v_perm_b32 v65, v28, v30, s10
    v_perm_b32 v75, v28, v30, s11
    v_perm_b32 v85, v29, v31, s10
    v_perm_b32 v95, v29, v31, s11
    ds_read_b64 v[40:41], v3 offset:36416
    ds_read_b64 v[42:43], v3 offset:36544
    ds_read_b64 v[44:45], v3 offset:36672
    ds_read_b64 v[46:47], v3 offset:36800
    v_dot2_f32_bf16 v96, v56, v49, 0
    v_dot2_f32_bf16 v104, v66, v51, 0
    v_dot2_f32_bf16 v112, v76, v53, 0
    v_dot2_f32_bf16 v120, v86, v55, 0
    v_dot2_f32_bf16 v97, v57, v49, 0
    v_dot2_f32_bf16 v105, v67, v51, 0
    v_dot2_f32_bf16 v113, v77, v53, 0
    v_dot2_f32_bf16 v121, v87, v55, 0
    v_dot2_f32_bf16 v98, v58, v49, 0
    v_dot2_f32_bf16 v106, v68, v51, 0
    v_dot2_f32_bf16 v114, v78, v53, 0
    v_dot2_f32_bf16 v122, v88, v55, 0
    v_dot2_f32_bf16 v99, v59, v49, 0
    v_dot2_f32_bf16 v107, v69, v51, 0
    v_dot2_f32_bf16 v115, v79, v53, 0
    v_dot2_f32_bf16 v123, v89, v55, 0
    v_dot2_f32_bf16 v100, v60, v49, 0
    v_dot2_f32_bf16 v108, v70, v51, 0
    v_dot2_f32_bf16 v116, v80, v53, 0
    v_dot2_f32_bf16 v124, v90, v55, 0
    v_dot2_f32_bf16 v101, v61, v49, 0
    v_dot2_f32_bf16 v109, v71, v51, 0
    v_dot2_f32_bf16 v117, v81, v53, 0
    v_dot2_f32_bf16 v125, v91, v55, 0
    v_dot2_f32_bf16 v102, v62, v49, 0
    v_dot2_f32_bf16 v110, v72, v51, 0
    v_dot2_f32_bf16 v118, v82, v53, 0
    v_dot2_f32_bf16 v126, v92, v55, 0
    v_dot2_f32_bf16 v103, v63, v49, 0
    v_dot2_f32_bf16 v111, v73, v51, 0
    v_dot2_f32_bf16 v119, v83, v53, 0
    v_dot2_f32_bf16 v127, v93, v55, 0
    v_dot2_f32_bf16 v96, v58, v48, v96
    v_dot2_f32_bf16 v104, v68, v50, v104
    v_dot2_f32_bf16 v112, v78, v52, v112
    v_dot2_f32_bf16 v120, v88, v54, v120
    v_dot2_f32_bf16 v97, v59, v48, v97
    v_dot2_f32_bf16 v105, v69, v50, v105
    v_dot2_f32_bf16 v113, v79, v52, v113
    v_dot2_f32_bf16 v121, v89, v54, v121
    v_dot2_f32_bf16 v98, v60, v48, v98
    v_dot2_f32_bf16 v106, v70, v50, v106
    v_dot2_f32_bf16 v114, v80, v52, v114
    v_dot2_f32_bf16 v122, v90, v54, v122
    v_dot2_f32_bf16 v99, v61, v48, v99
    v_dot2_f32_bf16 v107, v71, v50, v107
    v_dot2_f32_bf16 v115, v81, v52, v115
    v_dot2_f32_bf16 v123, v91, v54, v123
    v_dot2_f32_bf16 v100, v62, v48, v100
    v_dot2_f32_bf16 v108, v72, v50, v108
    v_dot2_f32_bf16 v116, v82, v52, v116
    v_dot2_f32_bf16 v124, v92, v54, v124
    v_dot2_f32_bf16 v101, v63, v48, v101
    v_dot2_f32_bf16 v109, v73, v50, v109
    v_dot2_f32_bf16 v117, v83, v52, v117
    v_dot2_f32_bf16 v125, v93, v54, v125
    v_dot2_f32_bf16 v102, v64, v48, v102
    v_dot2_f32_bf16 v110, v74, v50, v110
    v_dot2_f32_bf16 v118, v84, v52, v118
    v_dot2_f32_bf16 v126, v94, v54, v126
    v_dot2_f32_bf16 v103, v65, v48, v103
    v_dot2_f32_bf16 v111, v75, v50, v111
    v_dot2_f32_bf16 v119, v85, v52, v119
    v_dot2_f32_bf16 v127, v95, v54, v127
    s_waitcnt lgkmcnt(0)
    v_lshlrev_b32 v56, 16, v32
    v_lshlrev_b32 v57, 16, v34
    v_lshlrev_b32 v58, 16, v36
    v_lshlrev_b32 v59, 16, v38
    v_lshlrev_b32 v60, 16, v40
    v_lshlrev_b32 v61, 16, v42
    v_lshlrev_b32 v62, 16, v44
    v_lshlrev_b32 v63, 16, v46
    v_pk_mul_f32 v[96:97], v[96:97], v[56:57]
    v_pk_mul_f32 v[98:99], v[98:99], v[58:59]
    v_pk_mul_f32 v[100:101], v[100:101], v[60:61]
    v_pk_mul_f32 v[102:103], v[102:103], v[62:63]
    v_cvt_pk_bf16_f32 v128, v103, v102
    v_cvt_pk_bf16_f32 v129, v101, v100
    v_cvt_pk_bf16_f32 v130, v99, v98
    v_cvt_pk_bf16_f32 v131, v97, v96
    buffer_store_dwordx4 v[128:131], v6, s[52:55], 0 offen sc1
    v_and_b32 v64, 0xffff0000, v32
    v_and_b32 v65, 0xffff0000, v34
    v_and_b32 v66, 0xffff0000, v36
    v_and_b32 v67, 0xffff0000, v38
    v_and_b32 v68, 0xffff0000, v40
    v_and_b32 v69, 0xffff0000, v42
    v_and_b32 v70, 0xffff0000, v44
    v_and_b32 v71, 0xffff0000, v46
    v_pk_mul_f32 v[104:105], v[104:105], v[64:65]
    v_pk_mul_f32 v[106:107], v[106:107], v[66:67]
    v_pk_mul_f32 v[108:109], v[108:109], v[68:69]
    v_pk_mul_f32 v[110:111], v[110:111], v[70:71]
    v_cvt_pk_bf16_f32 v132, v111, v110
    v_cvt_pk_bf16_f32 v133, v109, v108
    v_cvt_pk_bf16_f32 v134, v107, v106
    v_cvt_pk_bf16_f32 v135, v105, v104
    buffer_store_dwordx4 v[132:135], v6, s[52:55], s12 offen sc1
    v_lshlrev_b32 v72, 16, v33
    v_lshlrev_b32 v73, 16, v35
    v_lshlrev_b32 v74, 16, v37
    v_lshlrev_b32 v75, 16, v39
    v_lshlrev_b32 v76, 16, v41
    v_lshlrev_b32 v77, 16, v43
    v_lshlrev_b32 v78, 16, v45
    v_lshlrev_b32 v79, 16, v47
    v_pk_mul_f32 v[112:113], v[112:113], v[72:73]
    v_pk_mul_f32 v[114:115], v[114:115], v[74:75]
    v_pk_mul_f32 v[116:117], v[116:117], v[76:77]
    v_pk_mul_f32 v[118:119], v[118:119], v[78:79]
    v_cvt_pk_bf16_f32 v136, v119, v118
    v_cvt_pk_bf16_f32 v137, v117, v116
    v_cvt_pk_bf16_f32 v138, v115, v114
    v_cvt_pk_bf16_f32 v139, v113, v112
    buffer_store_dwordx4 v[136:139], v6, s[52:55], s13 offen sc1
    v_and_b32 v80, 0xffff0000, v33
    v_and_b32 v81, 0xffff0000, v35
    v_and_b32 v82, 0xffff0000, v37
    v_and_b32 v83, 0xffff0000, v39
    v_and_b32 v84, 0xffff0000, v41
    v_and_b32 v85, 0xffff0000, v43
    v_and_b32 v86, 0xffff0000, v45
    v_and_b32 v87, 0xffff0000, v47
    v_pk_mul_f32 v[120:121], v[120:121], v[80:81]
    v_pk_mul_f32 v[122:123], v[122:123], v[82:83]
    v_pk_mul_f32 v[124:125], v[124:125], v[84:85]
    v_pk_mul_f32 v[126:127], v[126:127], v[86:87]
    v_cvt_pk_bf16_f32 v140, v127, v126
    v_cvt_pk_bf16_f32 v141, v125, v124
    v_cvt_pk_bf16_f32 v142, v123, v122
    v_cvt_pk_bf16_f32 v143, v121, v120
    buffer_store_dwordx4 v[140:143], v6, s[52:55], s14 offen sc1
    s_waitcnt vmcnt(4)
    ds_read_b128 v[144:147], v222 offset:32
    ds_read_b32 v160, v222 offset:28
    ds_read_b128 v[148:151], v222 offset:1056
    ds_read_b32 v161, v222 offset:1052
    ds_read_b128 v[152:155], v222 offset:2080
    ds_read_b32 v162, v222 offset:2076
    ds_read_b128 v[156:159], v222 offset:3104
    ds_read_b32 v163, v222 offset:3100
    s_waitcnt lgkmcnt(6)
    v_alignbit_b32 v164, v144, v160, 16
    v_alignbit_b32 v165, v145, v144, 16
    v_alignbit_b32 v166, v146, v145, 16
    v_alignbit_b32 v167, v147, v146, 16
    ds_write_b128 v222, v[164:167] offset:4192
    s_waitcnt lgkmcnt(5)
    v_alignbit_b32 v168, v148, v161, 16
    v_alignbit_b32 v169, v149, v148, 16
    v_alignbit_b32 v170, v150, v149, 16
    v_alignbit_b32 v171, v151, v150, 16
    ds_write_b128 v222, v[168:171] offset:5216
    s_waitcnt lgkmcnt(4)
    v_alignbit_b32 v172, v152, v162, 16
    v_alignbit_b32 v173, v153, v152, 16
    v_alignbit_b32 v174, v154, v153, 16
    v_alignbit_b32 v175, v155, v154, 16
    ds_write_b128 v222, v[172:175] offset:6240
    s_waitcnt lgkmcnt(3)
    v_alignbit_b32 v176, v156, v163, 16
    v_alignbit_b32 v177, v157, v156, 16
    v_alignbit_b32 v178, v158, v157, 16
    v_alignbit_b32 v179, v159, v158, 16
    ds_write_b128 v222, v[176:179] offset:7264
    s_waitcnt vmcnt(4)
    s_mov_b32 s40, s32
    s_and_b32 s41, s33, 0xffff
    s_mov_b32 s42, 663552
    s_mov_b32 s43, 0x20000
    s_sub_u32 s9, s5, 18
    s_lshl_b32 s9, s9, 3
    s_add_u32 s9, s9, s3
    s_mul_i32 s69, s9, 9216
    v_lshlrev_b32 v248, 7, v1
    v_add_u32 v249, 8192, v248
    s_mov_b32 s11, 0
L_ta_m:
    v_cmp_eq_u32 vcc, 0, v242
    s_cbranch_vccz L_ua_m
    s_mov_b32 s48, s36
    s_and_b32 s49, s37, 0xffff
    s_mov_b32 s50, 256
    s_mov_b32 s51, 0x20000
    v_mov_b32 v241, 0
    buffer_load_dwordx2 v[242:243], v241, s[48:51], 0 offen sc1
    s_waitcnt vmcnt(0)
    s_add_u32 s11, s11, 1
    s_cmp_lt_u32 s11, 65536
    s_cbranch_scc1 L_ta_m
L_ua_m:
    s_add_u32 s48, s38, 4718592
    s_addc_u32 s49, s39, 0
    s_and_b32 s49, s49, 0xffff
    s_mov_b32 s50, 27648
    s_mov_b32 s51, 0x20000
    v_mov_b32 v241, s68
    s_cmp_lg_u32 s3, 0
    s_waitcnt vmcnt(0)
    s_barrier
    s_cbranch_scc1 L_sa_m
    s_mov_b64 exec, 1
    buffer_store_dwordx2 v[242:243], v241, s[48:51], 0 offen sc1
    s_mov_b64 exec, -1
L_sa_m:
    buffer_load_dword v250, v248, s[40:43], s69 offen
    s_mov_b64 exec, 0xff
    buffer_load_dword v251, v249, s[40:43], s69 offen
    s_mov_b64 exec, -1
    s_cmp_lg_u32 s3, 0
    s_cbranch_scc1 L_wa_m
    s_mov_b64 exec, 255
L_pa_m:
    buffer_load_dwordx2 v[244:245], v233, s[48:51], 0 offen sc1
    s_waitcnt vmcnt(0)
    v_cmp_ne_u64 vcc, v[244:245], v[242:243]
    s_cbranch_vccz L_da_m
    s_sleep 1
    s_add_u32 s11, s11, 1
    s_cmp_lt_u32 s11, 65536
    s_cbranch_scc1 L_pa_m
L_da_m:
    s_mov_b64 exec, -1
L_wa_m:
    s_barrier
    s_mov_b32 s52, s38
    s_and_b32 s53, s39, 0xffff
    s_mov_b32 s54, 2359296
    s_mov_b32 s55, 0x20000
    s_mov_b32 s40, s16
    s_and_b32 s41, s17, 0xffff
    s_mov_b32 s42, 2359296
    s_mov_b32 s43, 0x20000
    s_mov_b32 s44, s34
    s_and_b32 s45, s35, 0xffff
    s_mov_b32 s46, 4718592
    s_mov_b32 s47, 0x20000
    s_mov_b32 s65, 32768
    buffer_load_dwordx4 v[196:199], v224, s[52:55], 0 offen offset:0 sc1
    buffer_load_dwordx4 v[200:203], v224, s[52:55], 0 offen offset:1024 sc1
    buffer_load_dwordx4 v[204:207], v224, s[52:55], 0 offen offset:2048 sc1
    buffer_load_dwordx4 v[208:211], v224, s[52:55], 0 offen offset:3072 sc1
    s_mov_b32 exec_hi, 0x0fffffff
    ds_write_b64 v225, v[228:229] offset:4096
    s_mov_b32 exec_hi, -1
    s_waitcnt lgkmcnt(0)
    ds_read2_b32 v[10:11], v212 offset0:0 offset1:1
    ds_read2_b32 v[12:13], v212 offset0:2 offset1:3
    ds_read2_b32 v[14:15], v212 offset0:128 offset1:129
    ds_read2_b32 v[16:17], v212 offset0:130 offset1:131
    ds_read2_b32 v[18:19], v213 offset0:0 offset1:1
    ds_read2_b32 v[20:21], v213 offset0:2 offset1:3
    ds_read2_b32 v[22:23], v213 offset0:128 offset1:129
    ds_read2_b32 v[24:25], v213 offset0:130 offset1:131
    ds_read2_b32 v[26:27], v214 offset0:0 offset1:1
    ds_read2_b32 v[28:29], v214 offset0:2 offset1:3
    ds_read2_b32 v[30:31], v214 offset0:128 offset1:129
    ds_read2_b32 v[32:33], v214 offset0:130 offset1:131
    ds_read2_b32 v[34:35], v215 offset0:0 offset1:1
    ds_read2_b32 v[36:37], v215 offset0:2 offset1:3
    ds_read2_b32 v[38:39], v215 offset0:128 offset1:129
    ds_read2_b32 v[40:41], v215 offset0:130 offset1:131
    s_and_b32 s61, s15, 1
    s_lshl_b32 s61, s61, 4
    s_lshr_b32 s62, s62, s61
    s_and_b32 s62, s62, 0xffff
    v_and_b32 v175, 1, v217
    v_lshlrev_b32 v175, 4, v175
    v_lshlrev_b32 v175, v175, s62
    v_lshrrev_b32 v174, 1, v217
    v_cmp_eq_u32 vcc, 0, v174
    s_nop 1
    v_cndmask_b32 v170, 0, v175, vcc
    v_cmp_eq_u32 vcc, 1, v174
    s_nop 1
    v_cndmask_b32 v171, 0, v175, vcc
    v_cmp_eq_u32 vcc, 2, v174
    s_nop 1
    v_cndmask_b32 v172, 0, v175, vcc
    v_cmp_eq_u32 vcc, 3, v174
    s_nop 1
    v_cndmask_b32 v173, 0, v175, vcc
    s_waitcnt vmcnt(3)
    ds_write_b128 v226, v[196:199] offset:0
    s_waitcnt vmcnt(2)
    ds_write_b128 v226, v[200:203] offset:1024
    s_waitcnt vmcnt(1)
    ds_write_b128 v226, v[204:207] offset:2048
    s_waitcnt vmcnt(0)
    ds_write_b128 v226, v[208:211] offset:3072
    s_mul_i32 s9, s15, 9216
    s_add_u32 s9, s9, 1024
    v_mul_u32_u24 v249, 2304, v1
    s_mov_b64 exec, 15
    buffer_load_dword v251, v249, s[44:47], s9 offen sc1
    s_mov_b64 exec, -1
    s_waitcnt lgkmcnt(0)
L_task_ma:
    ds_read_b128 v[58:61], v216 offset:1536
    ds_read_b128 v[62:65], v216 offset:1024
    ds_read_b128 v[66:69], v216 offset:512
    ds_read_b128 v[70:73], v216 offset:0
    ds_read_b128 v[42:45], v216 offset:3584
    ds_read_b128 v[46:49], v216 offset:3072
    ds_read_b128 v[50:53], v216 offset:2560
    ds_read_b128 v[54:57], v216 offset:2048
    s_waitcnt lgkmcnt(7)
    v_mfma_f32_16x16x32_bf16 v[138:141], v[170:173], v[58:61], 0
    s_waitcnt lgkmcnt(6)
    v_mfma_f32_16x16x32_bf16 v[142:145], v[170:173], v[62:65], 0
    s_waitcnt lgkmcnt(5)
    v_mfma_f32_16x16x32_bf16 v[146:149], v[170:173], v[66:69], 0
    s_waitcnt lgkmcnt(4)
    v_mfma_f32_16x16x32_bf16 v[150:153], v[170:173], v[70:73], 0
    s_mov_b32 s64, 0
    s_lshr_b32 s66, s3, 2
L_a2loop_ma:
    s_cmp_eq_u32 s66, 0
    s_cbranch_scc1 L_ap0_ma
    s_setprio 1
L_ap0_ma:
    s_waitcnt lgkmcnt(0)
    v_mfma_f32_16x16x32_bf16 v[138:141], v[18:21], v[50:53], v[138:141]
    ds_read_b128 v[106:109], v216 offset:3648
    v_mfma_f32_16x16x32_bf16 v[138:141], v[14:17], v[54:57], v[138:141]
    ds_read2_b32 v[74:75], v212 offset0:16 offset1:17
    v_mfma_f32_16x16x32_bf16 v[142:145], v[18:21], v[54:57], v[142:145]
    ds_read2_b32 v[76:77], v212 offset0:18 offset1:19
    v_mfma_f32_16x16x32_bf16 v[138:141], v[22:25], v[46:49], v[138:141]
    ds_read_b128 v[110:113], v216 offset:3136
    v_mfma_f32_16x16x32_bf16 v[142:145], v[22:25], v[50:53], v[142:145]
    ds_read2_b32 v[78:79], v212 offset0:144 offset1:145
    v_mfma_f32_16x16x32_bf16 v[146:149], v[22:25], v[54:57], v[146:149]
    ds_read2_b32 v[80:81], v212 offset0:146 offset1:147
    v_mfma_f32_16x16x32_bf16 v[138:141], v[10:13], v[58:61], v[138:141]
    ds_read_b128 v[114:117], v216 offset:2624
    v_mfma_f32_16x16x32_bf16 v[142:145], v[14:17], v[58:61], v[142:145]
    ds_read2_b32 v[82:83], v213 offset0:16 offset1:17
    ds_read2_b32 v[84:85], v213 offset0:18 offset1:19
    v_mfma_f32_16x16x32_bf16 v[146:149], v[18:21], v[58:61], v[146:149]
    ds_read_b128 v[118:121], v216 offset:2112
    v_mfma_f32_16x16x32_bf16 v[150:153], v[22:25], v[58:61], v[150:153]
    ds_read2_b32 v[86:87], v213 offset0:144 offset1:145
    v_mfma_f32_16x16x32_bf16 v[138:141], v[26:29], v[42:45], v[138:141]
    ds_read2_b32 v[88:89], v213 offset0:146 offset1:147
    v_mfma_f32_16x16x32_bf16 v[142:145], v[26:29], v[46:49], v[142:145]
    ds_read_b128 v[122:125], v216 offset:1600
    v_mfma_f32_16x16x32_bf16 v[146:149], v[26:29], v[50:53], v[146:149]
    ds_read2_b32 v[90:91], v214 offset0:16 offset1:17
    v_mfma_f32_16x16x32_bf16 v[150:153], v[26:29], v[54:57], v[150:153]
    ds_read2_b32 v[92:93], v214 offset0:18 offset1:19
    v_mfma_f32_16x16x32_bf16 v[142:145], v[10:13], v[62:65], v[142:145]
    ds_read_b128 v[126:129], v216 offset:1088
    ds_read2_b32 v[94:95], v214 offset0:144 offset1:145
    v_mfma_f32_16x16x32_bf16 v[146:149], v[14:17], v[62:65], v[146:149]
    ds_read2_b32 v[96:97], v214 offset0:146 offset1:147
    v_mfma_f32_16x16x32_bf16 v[150:153], v[18:21], v[62:65], v[150:153]
    ds_read_b128 v[130:133], v216 offset:576
    v_mfma_f32_16x16x32_bf16 v[142:145], v[30:33], v[42:45], v[142:145]
    ds_read2_b32 v[98:99], v215 offset0:16 offset1:17
    v_mfma_f32_16x16x32_bf16 v[146:149], v[30:33], v[46:49], v[146:149]
    ds_read2_b32 v[100:101], v215 offset0:18 offset1:19
    v_mfma_f32_16x16x32_bf16 v[150:153], v[30:33], v[50:53], v[150:153]
    ds_read_b128 v[134:137], v216 offset:64
    v_mfma_f32_16x16x32_bf16 v[146:149], v[10:13], v[66:69], v[146:149]
    ds_read2_b32 v[102:103], v215 offset0:144 offset1:145
    v_mfma_f32_16x16x32_bf16 v[150:153], v[14:17], v[66:69], v[150:153]
    ds_read2_b32 v[104:105], v215 offset0:146 offset1:147
    v_mfma_f32_16x16x32_bf16 v[146:149], v[34:37], v[42:45], v[146:149]
    v_mfma_f32_16x16x32_bf16 v[150:153], v[34:37], v[46:49], v[150:153]
    v_mfma_f32_16x16x32_bf16 v[150:153], v[10:13], v[70:73], v[150:153]
    v_mfma_f32_16x16x32_bf16 v[150:153], v[38:41], v[42:45], v[150:153]
    s_setprio 0
    s_waitcnt lgkmcnt(0)
    v_mfma_f32_16x16x32_bf16 v[138:141], v[82:85], v[114:117], v[138:141]
    ds_read_b128 v[42:45], v216 offset:3712
    v_mfma_f32_16x16x32_bf16 v[138:141], v[78:81], v[118:121], v[138:141]
    ds_read2_b32 v[10:11], v212 offset0:32 offset1:33
    v_mfma_f32_16x16x32_bf16 v[142:145], v[82:85], v[118:121], v[142:145]
    ds_read2_b32 v[12:13], v212 offset0:34 offset1:35
    v_mfma_f32_16x16x32_bf16 v[138:141], v[86:89], v[110:113], v[138:141]
    ds_read_b128 v[46:49], v216 offset:3200
    v_mfma_f32_16x16x32_bf16 v[142:145], v[86:89], v[114:117], v[142:145]
    ds_read2_b32 v[14:15], v212 offset0:160 offset1:161
    v_mfma_f32_16x16x32_bf16 v[146:149], v[86:89], v[118:121], v[146:149]
    ds_read2_b32 v[16:17], v212 offset0:162 offset1:163
    v_mfma_f32_16x16x32_bf16 v[138:141], v[74:77], v[122:125], v[138:141]
    ds_read_b128 v[50:53], v216 offset:2688
    v_mfma_f32_16x16x32_bf16 v[142:145], v[78:81], v[122:125], v[142:145]
    ds_read2_b32 v[18:19], v213 offset0:32 offset1:33
    ds_read2_b32 v[20:21], v213 offset0:34 offset1:35
    v_mfma_f32_16x16x32_bf16 v[146:149], v[82:85], v[122:125], v[146:149]
    ds_read_b128 v[54:57], v216 offset:2176
    v_mfma_f32_16x16x32_bf16 v[150:153], v[86:89], v[122:125], v[150:153]
    ds_read2_b32 v[22:23], v213 offset0:160 offset1:161
    v_mfma_f32_16x16x32_bf16 v[138:141], v[90:93], v[106:109], v[138:141]
    ds_read2_b32 v[24:25], v213 offset0:162 offset1:163
    v_mfma_f32_16x16x32_bf16 v[142:145], v[90:93], v[110:113], v[142:145]
    ds_read_b128 v[58:61], v216 offset:1664
    v_mfma_f32_16x16x32_bf16 v[146:149], v[90:93], v[114:117], v[146:149]
    ds_read2_b32 v[26:27], v214 offset0:32 offset1:33
    v_mfma_f32_16x16x32_bf16 v[150:153], v[90:93], v[118:121], v[150:153]
    ds_read2_b32 v[28:29], v214 offset0:34 offset1:35
    v_mfma_f32_16x16x32_bf16 v[142:145], v[74:77], v[126:129], v[142:145]
    ds_read_b128 v[62:65], v216 offset:1152
    ds_read2_b32 v[30:31], v214 offset0:160 offset1:161
    v_mfma_f32_16x16x32_bf16 v[146:149], v[78:81], v[126:129], v[146:149]
    ds_read2_b32 v[32:33], v214 offset0:162 offset1:163
    v_mfma_f32_16x16x32_bf16 v[150:153], v[82:85], v[126:129], v[150:153]
    ds_read_b128 v[66:69], v216 offset:640
    v_mfma_f32_16x16x32_bf16 v[142:145], v[94:97], v[106:109], v[142:145]
    ds_read2_b32 v[34:35], v215 offset0:32 offset1:33
    v_mfma_f32_16x16x32_bf16 v[146:149], v[94:97], v[110:113], v[146:149]
    ds_read2_b32 v[36:37], v215 offset0:34 offset1:35
    v_mfma_f32_16x16x32_bf16 v[150:153], v[94:97], v[114:117], v[150:153]
    ds_read_b128 v[70:73], v216 offset:128
    v_mfma_f32_16x16x32_bf16 v[146:149], v[74:77], v[130:133], v[146:149]
    ds_read2_b32 v[38:39], v215 offset0:160 offset1:161
    v_mfma_f32_16x16x32_bf16 v[150:153], v[78:81], v[130:133], v[150:153]
    ds_read2_b32 v[40:41], v215 offset0:162 offset1:163
    v_mfma_f32_16x16x32_bf16 v[146:149], v[98:101], v[106:109], v[146:149]
    v_mfma_f32_16x16x32_bf16 v[150:153], v[98:101], v[110:113], v[150:153]
    v_mfma_f32_16x16x32_bf16 v[150:153], v[74:77], v[134:137], v[150:153]
    v_mfma_f32_16x16x32_bf16 v[150:153], v[102:105], v[106:109], v[150:153]
    s_cmp_lg_u32 s64, 0
    s_cbranch_scc1 L_a2nq_ma
    s_mov_b32 s65, 73728
    buffer_load_dwordx4 v[180:183], v220, s[40:43], 0 offen
    buffer_load_dwordx4 v[184:187], v220, s[40:43], s65 offen
L_a2nq_ma:
    v_add_u32 v212, 128, v212
    v_add_u32 v213, 128, v213
    v_add_u32 v214, 128, v214
    v_add_u32 v215, 128, v215
    v_add_u32 v216, 128, v216
    s_add_u32 s64, s64, 1
    s_cmp_lt_u32 s64, 4
    s_cbranch_scc1 L_a2loop_ma
    s_waitcnt lgkmcnt(0)
    v_cvt_pk_bf16_f32 v42, v138, v139
    v_cvt_pk_bf16_f32 v43, v140, v141
    ds_write_b64 v218, v[42:43] offset:0
    v_cvt_pk_bf16_f32 v44, v142, v143
    v_cvt_pk_bf16_f32 v45, v144, v145
    ds_write_b64 v218, v[44:45] offset:512
    v_cvt_pk_bf16_f32 v46, v146, v147
    v_cvt_pk_bf16_f32 v47, v148, v149
    ds_write_b64 v218, v[46:47] offset:1024
    v_cvt_pk_bf16_f32 v48, v150, v151
    v_cvt_pk_bf16_f32 v49, v152, v153
    ds_write_b64 v218, v[48:49] offset:1536
    s_waitcnt lgkmcnt(0)
    s_barrier
    ds_read_b64_tr_b16 v[74:75], v219 offset:0
    ds_read_b64_tr_b16 v[76:77], v219 offset:33536
    ds_read_b64_tr_b16 v[78:79], v219 offset:128
    ds_read_b64_tr_b16 v[80:81], v219 offset:33664
    s_mov_b32 s64, 147456
    s_waitcnt vmcnt(0)
    s_waitcnt lgkmcnt(2)
    v_lshlrev_b32 v106, 16, v74
    v_lshlrev_b32 v107, 16, v180
    v_and_b32 v108, 0xffff0000, v74
    v_and_b32 v109, 0xffff0000, v180
    v_mul_f32 v106, v106, v107
    v_mul_f32 v108, v108, v109
    v_cvt_pk_bf16_f32 v74, v106, v108
    v_lshlrev_b32 v110, 16, v75
    v_lshlrev_b32 v111, 16, v181
    v_and_b32 v112, 0xffff0000, v75
    v_and_b32 v113, 0xffff0000, v181
    v_mul_f32 v110, v110, v111
    v_mul_f32 v112, v112, v113
    v_cvt_pk_bf16_f32 v75, v110, v112
    v_lshlrev_b32 v114, 16, v76
    v_lshlrev_b32 v115, 16, v182
    v_and_b32 v116, 0xffff0000, v76
    v_and_b32 v117, 0xffff0000, v182
    v_mul_f32 v114, v114, v115
    v_mul_f32 v116, v116, v117
    v_cvt_pk_bf16_f32 v76, v114, v116
    v_lshlrev_b32 v118, 16, v77
    v_lshlrev_b32 v119, 16, v183
    v_and_b32 v120, 0xffff0000, v77
    v_and_b32 v121, 0xffff0000, v183
    v_mul_f32 v118, v118, v119
    v_mul_f32 v120, v120, v121
    v_cvt_pk_bf16_f32 v77, v118, v120
    buffer_store_dwordx4 v[74:77], v221, s[44:47], 0 offen
    s_waitcnt lgkmcnt(0)
    v_lshlrev_b32 v106, 16, v78
    v_lshlrev_b32 v107, 16, v184
    v_and_b32 v108, 0xffff0000, v78
    v_and_b32 v109, 0xffff0000, v184
    v_mul_f32 v106, v106, v107
    v_mul_f32 v108, v108, v109
    v_cvt_pk_bf16_f32 v78, v106, v108
    v_lshlrev_b32 v110, 16, v79
    v_lshlrev_b32 v111, 16, v185
    v_and_b32 v112, 0xffff0000, v79
    v_and_b32 v113, 0xffff0000, v185
    v_mul_f32 v110, v110, v111
    v_mul_f32 v112, v112, v113
    v_cvt_pk_bf16_f32 v79, v110, v112
    v_lshlrev_b32 v114, 16, v80
    v_lshlrev_b32 v115, 16, v186
    v_and_b32 v116, 0xffff0000, v80
    v_and_b32 v117, 0xffff0000, v186
    v_mul_f32 v114, v114, v115
    v_mul_f32 v116, v116, v117
    v_cvt_pk_bf16_f32 v80, v114, v116
    v_lshlrev_b32 v118, 16, v81
    v_lshlrev_b32 v119, 16, v187
    v_and_b32 v120, 0xffff0000, v81
    v_and_b32 v121, 0xffff0000, v187
    v_mul_f32 v118, v118, v119
    v_mul_f32 v120, v120, v121
    v_cvt_pk_bf16_f32 v81, v118, v120
    buffer_store_dwordx4 v[78:81], v221, s[44:47], s64 offen
    s_endpgm
    .p2align 10
L_roleC_m:
    s_sub_u32 s6, s5, 27
    s_lshl_b32 s6, s6, 3
    s_add_u32 s6, s6, s3
    s_lshl_b32 s7, s6, 6
    v_add_u32 v2, s7, v1
    s_getpc_b64 s[8:9]
L_pc_m:
    s_sub_u32 s8, s8, L_pc_m-concat_heads__ssm_conv_h3__sliding_local_dilated__prompt_kernel
    s_subb_u32 s9, s9, 0
    v_lshlrev_b32 v3, 7, v2
    v_cmp_gt_u32 vcc, L_end_m-concat_heads__ssm_conv_h3__sliding_local_dilated__prompt_kernel, v3
    v_mov_b32 v5, s9
    v_add_co_u32 v4, s[10:11], s8, v3
    s_nop 1
    v_addc_co_u32 v5, s[10:11], 0, v5, s[10:11]
    s_and_saveexec_b64 s[12:13], vcc
    s_cbranch_execz L_nc_m
    global_load_dword v250, v[4:5], off
L_nc_m:
    s_mov_b64 exec, s[12:13]
    s_and_b32 s9, s3, 3
    s_mul_i32 s9, s9, 5
    s_add_u32 s9, s9, s5
    s_sub_u32 s9, s9, 27
    s_lshl_b32 s9, s9, 6
    s_lshr_b32 s14, s3, 2
    s_mul_i32 s14, s14, 5120
    s_add_u32 s62, s9, s14
    v_add_u32 v6, s62, v1
    v_add_u32 v6, 5808, v6
    v_mul_u32_u24 v11, 10382, v6
    v_lshrrev_b32 v11, 24, v11
    v_mul_u32_u24 v12, 1616, v11
    v_sub_u32 v12, v6, v12
    v_cmp_gt_u32 vcc, 1040, v12
    v_mul_u32_u24 v40, 1152, v12
    v_lshl_add_u32 v40, v11, 7, v40
    v_subrev_u32 v12, 1040, v12
    v_and_b32 v12, 0x3ff, v12
    v_mul_u32_u24 v13, 7282, v12
    v_lshrrev_b32 v13, 16, v13
    v_mul_u32_u24 v14, 9, v13
    v_sub_u32 v12, v12, v14
    v_lshl_add_u32 v13, v11, 6, v13
    v_mul_u32_u24 v13, 3456, v13
    v_mul_u32_u24 v14, 171, v12
    v_lshrrev_b32 v14, 9, v14
    v_mul_u32_u24 v14, 768, v14
    v_lshl_add_u32 v14, v12, 7, v14
    v_add_u32 v41, v13, v14
    v_mov_b32 v11, 2147483648
    v_cndmask_b32 v40, v11, v40, vcc
    v_cndmask_b32 v41, v41, v11, vcc
    s_lshr_b32 s77, s4, 1
    s_mul_i32 s77, s77, 288
    s_and_b32 s77, s77, 0xffffff80
    s_and_b32 s76, s4, 1
    s_mul_i32 s76, s76, 1181952
    s_waitcnt lgkmcnt(0)
    s_cmp_lg_u32 s2, 216
    s_cbranch_scc1 L_nl_m
    s_cmp_lg_u32 s3, 0
    s_cbranch_scc1 L_nl_m
    s_memrealtime s[60:61]
    s_mov_b32 s56, s36
    s_and_b32 s57, s37, 0xffff
    s_mov_b32 s58, 256
    s_mov_b32 s59, 0x20000
    s_waitcnt lgkmcnt(0)
    s_or_b32 s60, s60, 1
    v_mov_b32 v30, s60
    v_mov_b32 v31, s61
    v_mov_b32 v32, 0
    s_mov_b64 exec, 1
    buffer_store_dwordx2 v[30:31], v32, s[56:59], 0 offen sc1
    s_mov_b64 exec, -1
L_nl_m:
    s_mov_b32 s40, s28
    s_and_b32 s41, s29, 0xffff
    s_mov_b32 s42, 2359296
    s_mov_b32 s43, 0x20000
    s_mov_b32 s44, s30
    s_and_b32 s45, s31, 0xffff
    s_mov_b32 s46, 1990656
    s_mov_b32 s47, 0x20000
    buffer_load_dword v250, v40, s[40:43], s76 offen
    buffer_load_dword v251, v41, s[44:47], s77 offen
    v_add_u32 v6, s62, v1
    v_add_u32 v6, 7088, v6
    v_mul_u32_u24 v11, 10382, v6
    v_lshrrev_b32 v11, 24, v11
    v_mul_u32_u24 v12, 1616, v11
    v_sub_u32 v12, v6, v12
    v_cmp_gt_u32 vcc, 1040, v12
    v_mul_u32_u24 v42, 1152, v12
    v_lshl_add_u32 v42, v11, 7, v42
    v_subrev_u32 v12, 1040, v12
    v_and_b32 v12, 0x3ff, v12
    v_mul_u32_u24 v13, 7282, v12
    v_lshrrev_b32 v13, 16, v13
    v_mul_u32_u24 v14, 9, v13
    v_sub_u32 v12, v12, v14
    v_lshl_add_u32 v13, v11, 6, v13
    v_mul_u32_u24 v13, 3456, v13
    v_mul_u32_u24 v14, 171, v12
    v_lshrrev_b32 v14, 9, v14
    v_mul_u32_u24 v14, 768, v14
    v_lshl_add_u32 v14, v12, 7, v14
    v_add_u32 v43, v13, v14
    v_mov_b32 v11, 2147483648
    v_cndmask_b32 v42, v11, v42, vcc
    v_cndmask_b32 v43, v43, v11, vcc
    buffer_load_dword v250, v42, s[40:43], s76 offen
    buffer_load_dword v251, v43, s[44:47], s77 offen
    v_add_u32 v6, s62, v1
    v_add_u32 v6, 8368, v6
    v_mul_u32_u24 v11, 10382, v6
    v_lshrrev_b32 v11, 24, v11
    v_mul_u32_u24 v12, 1616, v11
    v_sub_u32 v12, v6, v12
    v_cmp_gt_u32 vcc, 1040, v12
    v_mul_u32_u24 v44, 1152, v12
    v_lshl_add_u32 v44, v11, 7, v44
    v_subrev_u32 v12, 1040, v12
    v_and_b32 v12, 0x3ff, v12
    v_mul_u32_u24 v13, 7282, v12
    v_lshrrev_b32 v13, 16, v13
    v_mul_u32_u24 v14, 9, v13
    v_sub_u32 v12, v12, v14
    v_lshl_add_u32 v13, v11, 6, v13
    v_mul_u32_u24 v13, 3456, v13
    v_mul_u32_u24 v14, 171, v12
    v_lshrrev_b32 v14, 9, v14
    v_mul_u32_u24 v14, 768, v14
    v_lshl_add_u32 v14, v12, 7, v14
    v_add_u32 v45, v13, v14
    v_mov_b32 v11, 2147483648
    v_cndmask_b32 v44, v11, v44, vcc
    v_cndmask_b32 v45, v45, v11, vcc
    buffer_load_dword v250, v44, s[40:43], s76 offen
    buffer_load_dword v251, v45, s[44:47], s77 offen
    v_add_u32 v6, s62, v1
    v_add_u32 v6, 9648, v6
    v_mul_u32_u24 v11, 10382, v6
    v_lshrrev_b32 v11, 24, v11
    v_mul_u32_u24 v12, 1616, v11
    v_sub_u32 v12, v6, v12
    v_cmp_gt_u32 vcc, 1040, v12
    v_mul_u32_u24 v46, 1152, v12
    v_lshl_add_u32 v46, v11, 7, v46
    v_subrev_u32 v12, 1040, v12
    v_and_b32 v12, 0x3ff, v12
    v_mul_u32_u24 v13, 7282, v12
    v_lshrrev_b32 v13, 16, v13
    v_mul_u32_u24 v14, 9, v13
    v_sub_u32 v12, v12, v14
    v_lshl_add_u32 v13, v11, 6, v13
    v_mul_u32_u24 v13, 3456, v13
    v_mul_u32_u24 v14, 171, v12
    v_lshrrev_b32 v14, 9, v14
    v_mul_u32_u24 v14, 768, v14
    v_lshl_add_u32 v14, v12, 7, v14
    v_add_u32 v47, v13, v14
    v_mov_b32 v11, 2147483648
    v_cndmask_b32 v46, v11, v46, vcc
    v_cndmask_b32 v47, v47, v11, vcc
    buffer_load_dword v250, v46, s[40:43], s76 offen
    buffer_load_dword v251, v47, s[44:47], s77 offen
    s_sub_u32 s9, s5, 27
    s_lshl_b32 s9, s9, 1
    s_lshl_b32 s6, s4, 3
    s_add_u32 s6, s6, s9
    s_add_u32 s9, s4, 64
    s_cmp_eq_u32 s5, 31
    s_cselect_b32 s6, s9, s6
    s_cselect_b32 s75, 1, 2
    s_mov_b32 s56, s24
    s_and_b32 s57, s25, 0xffff
    s_mov_b32 s58, 2359296
    s_mov_b32 s59, 0x20000
    s_lshl_b32 s15, s6, 3
    s_add_u32 s15, s15, s3
    s_lshl_b32 s60, s15, 12
    v_lshlrev_b32 v223, 4, v1
    v_add_u32 v224, s60, v223
    s_lshr_b32 s61, s15, 1
    s_lshl_b32 s61, s61, 2
    s_load_dword s62, s[26:27], s61
    s_add_u32 s61, s61, 16
    s_min_u32 s61, s61, 1148
    s_load_dword s74, s[26:27], s61
    s_mul_i32 s63, s3, 4288
    s_mul_i32 s67, s3, 2528
    s_add_u32 s67, s67, 34304
    v_add_u32 v222, s63, v223
    v_add_u32 v226, s67, v223
    v_lshlrev_b32 v227, 3, v1
    v_add_u32 v225, s67, v227
    v_add_u32 v227, s63, v227
    v_and_b32 v228, 15, v1
    v_lshrrev_b32 v229, 4, v1
    v_and_b32 v230, 1, v1
    v_cmp_eq_u32 vcc, 1, v230
    v_mov_b32 v231, 2116
    v_lshlrev_b32 v230, 5, v228
    v_cndmask_b32 v231, v231, 2, vcc
    v_lshl_add_u32 v231, v228, 1, v231
    v_lshl_add_u32 v231, v229, 4, v231
    v_add_u32 v212, s63, v231
    v_add_u32 v213, 1024, v212
    v_sub_u32 v231, 480, v230
    v_lshl_add_u32 v231, v229, 4, v231
    v_add_u32 v216, s67, v231
    v_lshl_add_u32 v231, v229, 3, v230
    v_add_u32 v218, s63, v231
    v_lshl_add_u32 v232, v229, 3, v228
    v_sub_u32 v217, 15, v232
    v_bfe_u32 v231, v1, 2, 2
    v_mul_u32_u24 v231, 4288, v231
    v_lshl_add_u32 v231, v229, 5, v231
    v_and_b32 v232, 3, v1
    v_lshl_add_u32 v231, v232, 3, v231
    s_add_u32 s66, s3, s6
    s_and_b32 s66, s66, 7
    s_lshl_b32 s64, s66, 8
    v_add_u32 v219, s64, v231
    s_lshl_b32 s64, s66, 7
    s_add_u32 s64, s64, 0
    v_add_u32 v231, s64, v1
    s_lshl_b32 s65, s6, 4
    v_mul_u32_u24 v220, 1152, v231
    v_add_u32 v220, s65, v220
    v_mul_u32_u24 v221, 2304, v231
    v_add_u32 v221, s65, v221
    s_add_u32 s68, s6, 144
    s_and_b32 s9, s68, 0xf8
    s_mul_i32 s68, s68, 128
    s_mul_i32 s9, s9, 128
    v_mul_u32_u24 v233, 128, v1
    v_add_u32 v233, s9, v233
    v_mov_b32 v228, 0
    v_mov_b32 v229, 0
    s_mov_b64 exec, 15
    ds_write_b64 v227, v[228:229] offset:0
    ds_write_b64 v227, v[228:229] offset:2112
    ds_write_b64 v227, v[228:229] offset:54528
    ds_write_b64 v227, v[228:229] offset:56640
    s_mov_b64 exec, -1
    s_add_u32 m0, s63, 32
    s_add_u32 s61, s60, 0
    buffer_load_dwordx4 v223, s[56:59], s61 offen offset:0 nt lds
    buffer_load_dwordx4 v223, s[56:59], s61 offen offset:1024 nt lds
    s_add_u32 m0, s63, 54560
    s_add_u32 s61, s60, 32768
    buffer_load_dwordx4 v223, s[56:59], s61 offen offset:0 nt lds
    buffer_load_dwordx4 v223, s[56:59], s61 offen offset:1024 nt lds
    s_mov_b32 s48, s36
    s_and_b32 s49, s37, 0xffff
    s_mov_b32 s50, 256
    s_mov_b32 s51, 0x20000
    v_mov_b32 v241, 0
    buffer_load_dwordx2 v[242:243], v241, s[48:51], 0 offen sc1
    s_waitcnt vmcnt(0)
    ds_read_b128 v[144:147], v222 offset:32
    ds_read_b32 v160, v222 offset:28
    ds_read_b128 v[148:151], v222 offset:1056
    ds_read_b32 v161, v222 offset:1052
    ds_read_b128 v[152:155], v222 offset:54560
    ds_read_b32 v162, v222 offset:54556
    ds_read_b128 v[156:159], v222 offset:55584
    ds_read_b32 v163, v222 offset:55580
    s_waitcnt lgkmcnt(6)
    v_alignbit_b32 v164, v144, v160, 16
    v_alignbit_b32 v165, v145, v144, 16
    v_alignbit_b32 v166, v146, v145, 16
    v_alignbit_b32 v167, v147, v146, 16
    ds_write_b128 v222, v[164:167] offset:2144
    s_waitcnt lgkmcnt(5)
    v_alignbit_b32 v168, v148, v161, 16
    v_alignbit_b32 v169, v149, v148, 16
    v_alignbit_b32 v170, v150, v149, 16
    v_alignbit_b32 v171, v151, v150, 16
    ds_write_b128 v222, v[168:171] offset:3168
    s_waitcnt lgkmcnt(4)
    v_alignbit_b32 v172, v152, v162, 16
    v_alignbit_b32 v173, v153, v152, 16
    v_alignbit_b32 v174, v154, v153, 16
    v_alignbit_b32 v175, v155, v154, 16
    ds_write_b128 v222, v[172:175] offset:56672
    s_waitcnt lgkmcnt(3)
    v_alignbit_b32 v176, v156, v163, 16
    v_alignbit_b32 v177, v157, v156, 16
    v_alignbit_b32 v178, v158, v157, 16
    v_alignbit_b32 v179, v159, v158, 16
    ds_write_b128 v222, v[176:179] offset:57696
    s_mov_b32 s11, 0
L_th_m:
    v_cmp_eq_u32 vcc, 0, v242
    s_cbranch_vccz L_uh_m
    s_mov_b32 s48, s36
    s_and_b32 s49, s37, 0xffff
    s_mov_b32 s50, 256
    s_mov_b32 s51, 0x20000
    v_mov_b32 v241, 0
    buffer_load_dwordx2 v[242:243], v241, s[48:51], 0 offen sc1
    s_waitcnt vmcnt(0)
    s_add_u32 s11, s11, 1
    s_cmp_lt_u32 s11, 65536
    s_cbranch_scc1 L_th_m
L_uh_m:
    s_add_u32 s48, s38, 4718592
    s_addc_u32 s49, s39, 0
    s_and_b32 s49, s49, 0xffff
    s_mov_b32 s50, 27648
    s_mov_b32 s51, 0x20000
    s_cmp_lg_u32 s3, 0
    s_cbranch_scc1 L_wh_m
    s_mov_b64 exec, 15
L_ph_m:
    buffer_load_dwordx2 v[244:245], v233, s[48:51], 0 offen sc1
    s_waitcnt vmcnt(0)
    v_cmp_ne_u64 vcc, v[244:245], v[242:243]
    s_cbranch_vccz L_dh_m
    s_sleep 1
    s_add_u32 s11, s11, 1
    s_cmp_lt_u32 s11, 65536
    s_cbranch_scc1 L_ph_m
L_dh_m:
    s_mov_b64 exec, -1
L_wh_m:
    s_barrier
    s_mov_b32 s52, s38
    s_and_b32 s53, s39, 0xffff
    s_mov_b32 s54, 2359296
    s_mov_b32 s55, 0x20000
    s_mov_b32 s40, s16
    s_and_b32 s41, s17, 0xffff
    s_mov_b32 s42, 2359296
    s_mov_b32 s43, 0x20000
    s_mov_b32 s44, s34
    s_and_b32 s45, s35, 0xffff
    s_mov_b32 s46, 4718592
    s_mov_b32 s47, 0x20000
    s_mov_b32 s65, 32768
    buffer_load_dwordx4 v[196:199], v224, s[52:55], 0 offen offset:2048 sc1
    buffer_load_dwordx4 v[200:203], v224, s[52:55], 0 offen offset:3072 sc1
    buffer_load_dwordx4 v[204:207], v224, s[52:55], s65 offen offset:2048 sc1
    buffer_load_dwordx4 v[208:211], v224, s[52:55], s65 offen offset:3072 sc1
    s_mov_b32 exec_hi, 0x0fffffff
    ds_write_b64 v225, v[228:229] offset:2048
    ds_write_b64 v225, v[228:229] offset:56576
    s_mov_b32 exec_hi, -1
    s_waitcnt lgkmcnt(0)
    ds_read2_b32 v[10:11], v212 offset0:0 offset1:1
    ds_read2_b32 v[12:13], v212 offset0:2 offset1:3
    ds_read2_b32 v[14:15], v212 offset0:128 offset1:129
    ds_read2_b32 v[16:17], v212 offset0:130 offset1:131
    ds_read2_b32 v[18:19], v213 offset0:0 offset1:1
    ds_read2_b32 v[20:21], v213 offset0:2 offset1:3
    ds_read2_b32 v[22:23], v213 offset0:128 offset1:129
    ds_read2_b32 v[24:25], v213 offset0:130 offset1:131
    s_and_b32 s61, s15, 1
    s_lshl_b32 s61, s61, 4
    s_lshr_b32 s62, s62, s61
    s_and_b32 s62, s62, 0xffff
    v_and_b32 v175, 1, v217
    v_lshlrev_b32 v175, 4, v175
    v_lshlrev_b32 v175, v175, s62
    v_lshrrev_b32 v174, 1, v217
    v_cmp_eq_u32 vcc, 0, v174
    s_nop 1
    v_cndmask_b32 v170, 0, v175, vcc
    v_cmp_eq_u32 vcc, 1, v174
    s_nop 1
    v_cndmask_b32 v171, 0, v175, vcc
    v_cmp_eq_u32 vcc, 2, v174
    s_nop 1
    v_cndmask_b32 v172, 0, v175, vcc
    v_cmp_eq_u32 vcc, 3, v174
    s_nop 1
    v_cndmask_b32 v173, 0, v175, vcc
    s_waitcnt vmcnt(3)
    ds_write_b128 v226, v[196:199] offset:0
    s_waitcnt vmcnt(2)
    ds_write_b128 v226, v[200:203] offset:1024
    s_waitcnt vmcnt(1)
    ds_write_b128 v226, v[204:207] offset:54528
    s_waitcnt vmcnt(0)
    ds_write_b128 v226, v[208:211] offset:55552
    s_waitcnt lgkmcnt(0)
L_task_mh:
    ds_read_b128 v[42:45], v216 offset:1536
    ds_read_b128 v[46:49], v216 offset:1024
    ds_read_b128 v[50:53], v216 offset:512
    ds_read_b128 v[54:57], v216 offset:0
    s_waitcnt lgkmcnt(3)
    v_mfma_f32_16x16x32_bf16 v[138:141], v[170:173], v[42:45], 0
    s_waitcnt lgkmcnt(2)
    v_mfma_f32_16x16x32_bf16 v[142:145], v[170:173], v[46:49], 0
    s_waitcnt lgkmcnt(1)
    v_mfma_f32_16x16x32_bf16 v[146:149], v[170:173], v[50:53], 0
    s_waitcnt lgkmcnt(0)
    v_mfma_f32_16x16x32_bf16 v[150:153], v[170:173], v[54:57], 0
    s_mov_b32 s64, 0
    s_lshr_b32 s66, s3, 2
L_a2loop_mh:
    s_cmp_eq_u32 s66, 0
    s_cbranch_scc1 L_ap0_mh
    s_setprio 1
L_ap0_mh:
    s_waitcnt lgkmcnt(0)
    v_mfma_f32_16x16x32_bf16 v[138:141], v[10:13], v[42:45], v[138:141]
    ds_read_b128 v[106:109], v216 offset:1600
    v_mfma_f32_16x16x32_bf16 v[142:145], v[10:13], v[46:49], v[142:145]
    ds_read2_b32 v[74:75], v212 offset0:16 offset1:17
    v_mfma_f32_16x16x32_bf16 v[142:145], v[14:17], v[42:45], v[142:145]
    ds_read2_b32 v[76:77], v212 offset0:18 offset1:19
    ds_read_b128 v[110:113], v216 offset:1088
    v_mfma_f32_16x16x32_bf16 v[146:149], v[14:17], v[46:49], v[146:149]
    ds_read2_b32 v[78:79], v212 offset0:144 offset1:145
    ds_read2_b32 v[80:81], v212 offset0:146 offset1:147
    v_mfma_f32_16x16x32_bf16 v[146:149], v[10:13], v[50:53], v[146:149]
    ds_read_b128 v[114:117], v216 offset:576
    v_mfma_f32_16x16x32_bf16 v[150:153], v[14:17], v[50:53], v[150:153]
    ds_read2_b32 v[82:83], v213 offset0:16 offset1:17
    ds_read2_b32 v[84:85], v213 offset0:18 offset1:19
    v_mfma_f32_16x16x32_bf16 v[146:149], v[18:21], v[42:45], v[146:149]
    ds_read_b128 v[118:121], v216 offset:64
    ds_read2_b32 v[86:87], v213 offset0:144 offset1:145
    v_mfma_f32_16x16x32_bf16 v[150:153], v[18:21], v[46:49], v[150:153]
    ds_read2_b32 v[88:89], v213 offset0:146 offset1:147
    v_mfma_f32_16x16x32_bf16 v[150:153], v[10:13], v[54:57], v[150:153]
    v_mfma_f32_16x16x32_bf16 v[150:153], v[22:25], v[42:45], v[150:153]
    s_setprio 0
    s_waitcnt lgkmcnt(0)
    v_mfma_f32_16x16x32_bf16 v[138:141], v[74:77], v[106:109], v[138:141]
    ds_read_b128 v[42:45], v216 offset:1664
    v_mfma_f32_16x16x32_bf16 v[142:145], v[74:77], v[110:113], v[142:145]
    ds_read2_b32 v[10:11], v212 offset0:32 offset1:33
    v_mfma_f32_16x16x32_bf16 v[142:145], v[78:81], v[106:109], v[142:145]
    ds_read2_b32 v[12:13], v212 offset0:34 offset1:35
    ds_read_b128 v[46:49], v216 offset:1152
    v_mfma_f32_16x16x32_bf16 v[146:149], v[78:81], v[110:113], v[146:149]
    ds_read2_b32 v[14:15], v212 offset0:160 offset1:161
    ds_read2_b32 v[16:17], v212 offset0:162 offset1:163
    v_mfma_f32_16x16x32_bf16 v[146:149], v[74:77], v[114:117], v[146:149]
    ds_read_b128 v[50:53], v216 offset:640
    v_mfma_f32_16x16x32_bf16 v[150:153], v[78:81], v[114:117], v[150:153]
    ds_read2_b32 v[18:19], v213 offset0:32 offset1:33
    ds_read2_b32 v[20:21], v213 offset0:34 offset1:35
    v_mfma_f32_16x16x32_bf16 v[146:149], v[82:85], v[106:109], v[146:149]
    ds_read_b128 v[54:57], v216 offset:128
    ds_read2_b32 v[22:23], v213 offset0:160 offset1:161
    v_mfma_f32_16x16x32_bf16 v[150:153], v[82:85], v[110:113], v[150:153]
    ds_read2_b32 v[24:25], v213 offset0:162 offset1:163
    v_mfma_f32_16x16x32_bf16 v[150:153], v[74:77], v[118:121], v[150:153]
    v_mfma_f32_16x16x32_bf16 v[150:153], v[86:89], v[106:109], v[150:153]
    s_cmp_lg_u32 s64, 0
    s_cbranch_scc1 L_a2nq_mh
    s_mov_b32 s65, 73728
    buffer_load_dwordx4 v[180:183], v220, s[40:43], 0 offen
    buffer_load_dwordx4 v[184:187], v220, s[40:43], s65 offen
L_a2nq_mh:
    v_add_u32 v212, 128, v212
    v_add_u32 v213, 128, v213
    v_add_u32 v216, 128, v216
    s_add_u32 s64, s64, 1
    s_cmp_lt_u32 s64, 4
    s_cbranch_scc1 L_a2loop_mh
    s_waitcnt lgkmcnt(0)
    v_cvt_pk_bf16_f32 v42, v138, v139
    v_cvt_pk_bf16_f32 v43, v140, v141
    ds_write_b64 v218, v[42:43] offset:0
    v_cvt_pk_bf16_f32 v44, v142, v143
    v_cvt_pk_bf16_f32 v45, v144, v145
    ds_write_b64 v218, v[44:45] offset:512
    v_cvt_pk_bf16_f32 v46, v146, v147
    v_cvt_pk_bf16_f32 v47, v148, v149
    ds_write_b64 v218, v[46:47] offset:1024
    v_cvt_pk_bf16_f32 v48, v150, v151
    v_cvt_pk_bf16_f32 v49, v152, v153
    ds_write_b64 v218, v[48:49] offset:1536
    v_add_u32 v212, 54016, v212
    v_add_u32 v213, 54016, v213
    v_add_u32 v216, 54016, v216
    ds_read2_b32 v[10:11], v212 offset0:0 offset1:1
    ds_read2_b32 v[12:13], v212 offset0:2 offset1:3
    ds_read2_b32 v[14:15], v212 offset0:128 offset1:129
    ds_read2_b32 v[16:17], v212 offset0:130 offset1:131
    ds_read2_b32 v[18:19], v213 offset0:0 offset1:1
    ds_read2_b32 v[20:21], v213 offset0:2 offset1:3
    ds_read2_b32 v[22:23], v213 offset0:128 offset1:129
    ds_read2_b32 v[24:25], v213 offset0:130 offset1:131
    s_mov_b32 s62, s74
    s_waitcnt lgkmcnt(8)
    s_barrier
    ds_read_b64_tr_b16 v[74:75], v219 offset:0
    ds_read_b64_tr_b16 v[76:77], v219 offset:17152
    ds_read_b64_tr_b16 v[78:79], v219 offset:128
    ds_read_b64_tr_b16 v[80:81], v219 offset:17280
    s_mov_b32 s64, 147456
    s_waitcnt vmcnt(0)
    s_waitcnt lgkmcnt(2)
    v_lshlrev_b32 v106, 16, v74
    v_lshlrev_b32 v107, 16, v180
    v_and_b32 v108, 0xffff0000, v74
    v_and_b32 v109, 0xffff0000, v180
    v_mul_f32 v106, v106, v107
    v_mul_f32 v108, v108, v109
    v_cvt_pk_bf16_f32 v74, v106, v108
    v_lshlrev_b32 v110, 16, v75
    v_lshlrev_b32 v111, 16, v181
    v_and_b32 v112, 0xffff0000, v75
    v_and_b32 v113, 0xffff0000, v181
    v_mul_f32 v110, v110, v111
    v_mul_f32 v112, v112, v113
    v_cvt_pk_bf16_f32 v75, v110, v112
    v_lshlrev_b32 v114, 16, v76
    v_lshlrev_b32 v115, 16, v182
    v_and_b32 v116, 0xffff0000, v76
    v_and_b32 v117, 0xffff0000, v182
    v_mul_f32 v114, v114, v115
    v_mul_f32 v116, v116, v117
    v_cvt_pk_bf16_f32 v76, v114, v116
    v_lshlrev_b32 v118, 16, v77
    v_lshlrev_b32 v119, 16, v183
    v_and_b32 v120, 0xffff0000, v77
    v_and_b32 v121, 0xffff0000, v183
    v_mul_f32 v118, v118, v119
    v_mul_f32 v120, v120, v121
    v_cvt_pk_bf16_f32 v77, v118, v120
    buffer_store_dwordx4 v[74:77], v221, s[44:47], 0 offen
    s_waitcnt lgkmcnt(0)
    v_lshlrev_b32 v106, 16, v78
    v_lshlrev_b32 v107, 16, v184
    v_and_b32 v108, 0xffff0000, v78
    v_and_b32 v109, 0xffff0000, v184
    v_mul_f32 v106, v106, v107
    v_mul_f32 v108, v108, v109
    v_cvt_pk_bf16_f32 v78, v106, v108
    v_lshlrev_b32 v110, 16, v79
    v_lshlrev_b32 v111, 16, v185
    v_and_b32 v112, 0xffff0000, v79
    v_and_b32 v113, 0xffff0000, v185
    v_mul_f32 v110, v110, v111
    v_mul_f32 v112, v112, v113
    v_cvt_pk_bf16_f32 v79, v110, v112
    v_lshlrev_b32 v114, 16, v80
    v_lshlrev_b32 v115, 16, v186
    v_and_b32 v116, 0xffff0000, v80
    v_and_b32 v117, 0xffff0000, v186
    v_mul_f32 v114, v114, v115
    v_mul_f32 v116, v116, v117
    v_cvt_pk_bf16_f32 v80, v114, v116
    v_lshlrev_b32 v118, 16, v81
    v_lshlrev_b32 v119, 16, v187
    v_and_b32 v120, 0xffff0000, v81
    v_and_b32 v121, 0xffff0000, v187
    v_mul_f32 v118, v118, v119
    v_mul_f32 v120, v120, v121
    v_cvt_pk_bf16_f32 v81, v118, v120
    buffer_store_dwordx4 v[78:81], v221, s[44:47], s64 offen
    s_sub_u32 s75, s75, 1
    s_cmp_eq_u32 s75, 0
    s_cbranch_scc1 L_tdone_mh
    s_and_b32 s61, s15, 1
    s_lshl_b32 s61, s61, 4
    s_lshr_b32 s62, s62, s61
    s_and_b32 s62, s62, 0xffff
    v_and_b32 v175, 1, v217
    v_lshlrev_b32 v175, 4, v175
    v_lshlrev_b32 v175, v175, s62
    v_lshrrev_b32 v174, 1, v217
    v_cmp_eq_u32 vcc, 0, v174
    s_nop 1
    v_cndmask_b32 v170, 0, v175, vcc
    v_cmp_eq_u32 vcc, 1, v174
    s_nop 1
    v_cndmask_b32 v171, 0, v175, vcc
    v_cmp_eq_u32 vcc, 2, v174
    s_nop 1
    v_cndmask_b32 v172, 0, v175, vcc
    v_cmp_eq_u32 vcc, 3, v174
    s_nop 1
    v_cndmask_b32 v173, 0, v175, vcc
    v_add_u32 v218, 54528, v218
    v_add_u32 v219, 54528, v219
    v_add_u32 v220, 16, v220
    v_add_u32 v221, 16, v221
    s_branch L_task_mh
L_tdone_mh:
L_end_m:
    s_endpgm
.section .rodata,"a"
.p2align 6
.amdhsa_kernel concat_heads__ssm_conv_h3__sliding_local_dilated__prompt_kernel
  .amdhsa_next_free_vgpr 256
  .amdhsa_next_free_sgpr 102
  .amdhsa_accum_offset 256
  .amdhsa_group_segment_fixed_size 0
  .amdhsa_kernarg_size 96
  .amdhsa_user_sgpr_count 2
  .amdhsa_user_sgpr_kernarg_segment_ptr 1
  .amdhsa_system_sgpr_workgroup_id_x 1
.end_amdhsa_kernel
```
